```python
import torch

def _softmax(x, axis=-1):
    return torch.softmax(x, dim=axis)
def _gelu(x):
    return torch.nn.functional.gelu(x, approximate="tanh")
def _silu(x):
    return torch.nn.functional.silu(x)
def _sigmoid(x):
    return torch.sigmoid(x)
def _layernorm(x, axis=-1, eps=1e-5):
    m = x.mean(dim=axis, keepdim=True)
    v = x.var(dim=axis, keepdim=True, unbiased=False)
    return (x - m) / torch.sqrt(v + eps)
def _scatter_add(tgt, idx, src, axis=0):
    return tgt.clone().index_add_(axis, idx, src)
def _segment_sum(src, seg, n):
    out = torch.zeros((n,) + src.shape[1:], dtype=src.dtype)
    return out.index_add_(0, seg, src)
def _pad(x, pw):
    flat = tuple(v for pair in reversed(pw) for v in pair)
    return torch.nn.functional.pad(x, flat)

kernel_name = 'standalone__gqa_softmax__near_ridge'

def setup_inputs():

    _w = (lambda a: (lambda t: t.to(torch.bfloat16) if t.is_floating_point() else t)(torch.as_tensor(a)))
    B, Hq, Hkv, Sq, Sk, D = 8, 32, 8, 112, 1024, 128
    return {
        "q": _w((lambda *s: torch.randn(*s, dtype=torch.bfloat16) * 0.8)(B, Hq, Sq, D)),
        "k": _w((lambda *s: torch.randn(*s, dtype=torch.bfloat16) * 0.8)(B, Hkv, Sk, D)),
        "v": _w((lambda *s: torch.randn(*s, dtype=torch.bfloat16) * 0.05)(B, Hkv, Sk, D)),
    }

def reference(q, k, v):
    B, Hq, Sq, D = q.shape
    Hkv = k.shape[1]
    rep = Hq // Hkv
    k = (lambda x, n, axis: torch.repeat_interleave(x, n, dim=axis))(k, rep, axis=1)
    v = (lambda x, n, axis: torch.repeat_interleave(x, n, dim=axis))(v, rep, axis=1)
    scale = D ** -0.5
    scores = torch.einsum("bhqd,bhkd->bhqk", q, k) * scale
    p = _softmax(scores, axis=-1)
    return torch.einsum("bhqk,bhkd->bhqd", p, v)
```

```asm
; @launch grid=(256,1,1) block=(256,1,1) lds=163840
.amdgcn_target "amdgcn-amd-amdhsa--gfx950"
.text
.globl standalone__gqa_softmax__near_ridge_kernel
.p2align 12
.p2align 8
.type standalone__gqa_softmax__near_ridge_kernel,@function
standalone__gqa_softmax__near_ridge_kernel:
    s_cmp_ge_u32 s2, 256
    s_cbranch_scc1 L_end
    s_load_dwordx8 s[4:11], s[0:1], 0
    v_lshrrev_b32 v1, 6, v0
    v_and_b32 v0, 63, v0
    v_readfirstlane_b32 s28, v1
    s_getpc_b64 s[24:25]
    s_cmp_lg_u32 s28, 3
    s_cbranch_scc1 L_nopf
    s_and_b32 s24, s24, 0xfffff000
    s_lshr_b32 s29, s2, 3
    s_add_u32 s29, s29, 1
    s_min_u32 s29, s29, 19
    s_lshl_b32 s29, s29, 10
    s_add_u32 s24, s24, s29
    s_addc_u32 s25, s25, 0
    v_lshl_add_u32 v2, v0, 4, s24
    v_mov_b32 v3, s25
    global_load_dwordx4 v[24:27], v[2:3], off
L_nopf:
    s_mov_b32 s3, -1
L_start:
    s_and_b32 s29, s2, 7
    s_lshr_b32 s30, s2, 3
    s_and_b32 s31, s30, 3
    s_lshr_b32 s30, s30, 2
    s_lshl_b32 s29, s29, 3
    s_or_b32 s30, s30, s29
    s_lshl_b32 s32, s30, 2
    s_or_b32 s32, s32, s31
    s_mul_i32 s32, s32, 28672
    s_lshl_b32 s33, s30, 18
    v_lshrrev_b32 v1, 4, v0
    v_and_b32 v2, 15, v0
    v_lshlrev_b32 v3, 8, v1
    v_xor_b32 v17, v2, v1
    v_lshl_add_u32 v18, v17, 4, v3
    v_mov_b32 v4, v18
    v_xor_b32 v5, 64, v4
    v_xor_b32 v6, 128, v4
    v_xor_b32 v7, 192, v4
    s_lshl_b32 s39, s28, 6
    v_xor_b32 v19, s39, v18
    s_lshl_b32 s39, s28, 10
    v_add_u32 v19, s39, v19
    v_lshlrev_b32 v18, 2, v1
    v_xor_b32 v18, v18, v2
    v_lshl_add_u32 v8, v18, 4, v3
    s_mul_i32 s34, s28, 40960
    s_lshl_b32 s38, s28, 13
    s_lshr_b32 s35, s30, 3
    s_xor_b32 s35, s35, s30
    s_and_b32 s35, s35, 7
    s_lshl_b32 s35, s35, 15
    s_or_b32 s38, s38, s35
    s_lshl_b32 s30, s31, 11
    s_or_b32 s48, s38, s30
    s_xor_b32 s49, s48, 2048
    s_xor_b32 s50, s48, 4096
    s_andn2_b32 s50, s50, 2048
    s_mov_b32 s18, 262144
    s_mov_b32 s19, 0x20000
    s_mov_b32 s22, 262144
    s_mov_b32 s23, 0x20000
    s_mov_b32 s14, 28672
    s_mov_b32 s15, 0x20000
    s_waitcnt lgkmcnt(0)
    s_add_u32 s12, s4, s32
    s_addc_u32 s13, s5, 0
    buffer_load_dwordx4 v[104:107], v19, s[12:15], 0 offen
    s_add_u32 s16, s6, s33
    s_addc_u32 s17, s7, 0
    s_add_u32 s20, s8, s33
    s_addc_u32 s21, s9, 0
    s_add_u32 m0, s34, 0
    s_nop 0
    buffer_load_dwordx4 v4, s[16:19], s48 offen lds
    buffer_load_dwordx4 v5, s[16:19], s48 offen offset:1024 lds
    v_lshlrev_b32 v42, 4, v1
    v_add_u32 v44, 128, v42
    s_add_u32 s24, s10, s32
    s_addc_u32 s25, s11, 0
    v_lshlrev_b32 v3, 8, v2
    v_add_u32 v3, s34, v3
    v_lshl_add_u32 v9, v17, 4, v3
    v_xor_b32 v18, 4, v17
    v_lshl_add_u32 v10, v18, 4, v3
    s_mov_b32 s39, 4096
    buffer_load_dwordx4 v[108:111], v19, s[12:15], s39 offen
    v_xor_b32 v18, 8, v17
    v_lshl_add_u32 v11, v18, 4, v3
    v_xor_b32 v18, 12, v17
    v_lshl_add_u32 v12, v18, 4, v3
    s_mov_b32 s36, 0x3e0293ee
    s_mov_b32 s37, s36
    s_mov_b32 s38, 0xffff0000
    v_lshlrev_b32 v1, 4, v0
    s_lshl_b32 s29, s28, 10
    s_mov_b32 s39, 8192
    buffer_load_dwordx4 v[112:115], v19, s[12:15], s39 offen
    s_add_u32 s29, s29, 32768
    v_add_u32 v40, s29, v1
    v_add_u32 v41, 81920, v40
    v_add_u32 v1, s34, v1
    v_mov_b32 v43, 0x80008000
    s_sub_u32 s29, 32768, s34
    v_add_u32 v152, s29, v9
    v_add_u32 v156, 81920, v152
    v_add_u32 v153, s29, v10
    s_add_u32 m0, s34, 2048
    s_nop 0
    buffer_load_dwordx4 v6, s[16:19], s49 offen lds
    v_add_u32 v157, 81920, v153
    v_add_u32 v154, s29, v11
    v_add_u32 v158, 81920, v154
    v_add_u32 v155, s29, v12
    v_add_u32 v159, 81920, v155
    s_xor_b32 s52, s48, 32768
    s_xor_b32 s53, s49, 32768
    s_xor_b32 s54, s50, 32768
    s_not_b32 s29, s3
    buffer_load_dwordx4 v7, s[16:19], s49 offen offset:1024 lds
    v_and_b32 v48, s29, v48
    v_and_b32 v49, s29, v49
    v_and_b32 v50, s29, v50
    v_and_b32 v51, s29, v51
    v_and_b32 v52, s29, v52
    v_and_b32 v53, s29, v53
    v_and_b32 v54, s29, v54
    v_and_b32 v55, s29, v55
    v_and_b32 v56, s29, v56
    s_add_u32 m0, s34, 4096
    s_nop 0
    buffer_load_dwordx4 v4, s[16:19], s50 offen lds
    v_and_b32 v57, s29, v57
    v_and_b32 v58, s29, v58
    v_and_b32 v59, s29, v59
    v_and_b32 v60, s29, v60
    v_and_b32 v61, s29, v61
    v_and_b32 v62, s29, v62
    v_and_b32 v63, s29, v63
    v_and_b32 v64, s29, v64
    v_and_b32 v65, s29, v65
    buffer_load_dwordx4 v5, s[16:19], s50 offen offset:1024 lds
    v_and_b32 v66, s29, v66
    v_and_b32 v67, s29, v67
    v_and_b32 v68, s29, v68
    v_and_b32 v69, s29, v69
    v_and_b32 v70, s29, v70
    v_and_b32 v71, s29, v71
    v_and_b32 v72, s29, v72
    v_and_b32 v73, s29, v73
    v_and_b32 v74, s29, v74
    buffer_load_dwordx4 v6, s[16:19], s50 offen offset:2048 lds
    v_and_b32 v75, s29, v75
    v_lshrrev_b32 v3, 2, v0
    v_lshlrev_b32 v3, 8, v3
    v_add_u32 v3, s34, v3
    v_add_u32 v3, 16384, v3
    s_add_u32 s35, s28, 0
    s_and_b32 s35, s35, 3
    s_lshl_b32 s35, s35, 2
    v_xor_b32 v18, s35, v2
    v_lshl_add_u32 v13, v18, 4, v3
    s_add_u32 s35, s28, 1
    s_and_b32 s35, s35, 3
    s_lshl_b32 s35, s35, 2
    v_xor_b32 v18, s35, v2
    v_lshl_add_u32 v14, v18, 4, v3
    s_add_u32 s35, s28, 2
    s_and_b32 s35, s35, 3
    s_lshl_b32 s35, s35, 2
    v_xor_b32 v18, s35, v2
    v_lshl_add_u32 v15, v18, 4, v3
    s_add_u32 s35, s28, 3
    s_and_b32 s35, s35, 3
    s_lshl_b32 s35, s35, 2
    v_xor_b32 v18, s35, v2
    v_lshl_add_u32 v16, v18, 4, v3
    v_mov_b32 v20, 0x3f803f80
    v_mov_b32 v21, 0x3f803f80
    v_mov_b32 v22, 0x3f803f80
    v_mov_b32 v23, 0x3f803f80
    s_xor_b32 s56, s48, 65536
    s_xor_b32 s60, s48, 98304
    s_xor_b32 s64, s48, 131072
    s_xor_b32 s68, s48, 163840
    s_xor_b32 s72, s48, 196608
    s_xor_b32 s76, s48, 229376
    s_xor_b32 s57, s49, 65536
    s_xor_b32 s61, s49, 98304
    s_xor_b32 s65, s49, 131072
    s_xor_b32 s69, s49, 163840
    s_xor_b32 s73, s49, 196608
    s_xor_b32 s77, s49, 229376
    s_xor_b32 s58, s50, 65536
    s_xor_b32 s62, s50, 98304
    s_xor_b32 s66, s50, 131072
    s_xor_b32 s70, s50, 163840
    s_xor_b32 s74, s50, 196608
    s_xor_b32 s78, s50, 229376
    s_mov_b32 s26, 28672
    s_mov_b32 s27, 0x20000
    s_waitcnt vmcnt(9)
    buffer_load_dwordx4 v7, s[16:19], s50 offen offset:3072 lds
    s_mov_b32 s39, 12288
    buffer_load_dwordx4 v[116:119], v19, s[12:15], s39 offen
    s_mov_b32 s39, 16384
    buffer_load_dwordx4 v[120:123], v19, s[12:15], s39 offen
    v_lshlrev_b32 v248, 16, v104
    v_and_b32 v249, s38, v104
    v_lshlrev_b32 v250, 16, v105
    v_and_b32 v251, s38, v105
    v_lshlrev_b32 v252, 16, v106
    v_and_b32 v253, s38, v106
    v_lshlrev_b32 v254, 16, v107
    v_and_b32 v255, s38, v107
    v_pk_mul_f32 v[248:249], v[248:249], s[36:37]
    v_pk_mul_f32 v[250:251], v[250:251], s[36:37]
    v_pk_mul_f32 v[252:253], v[252:253], s[36:37]
    v_pk_mul_f32 v[254:255], v[254:255], s[36:37]
    v_cvt_pk_bf16_f32 v104, v248, v249
    v_cvt_pk_bf16_f32 v105, v250, v251
    v_cvt_pk_bf16_f32 v106, v252, v253
    v_cvt_pk_bf16_f32 v107, v254, v255
    ds_write_b128 v40, v[104:107] offset:0
    s_waitcnt vmcnt(9)
    s_mov_b32 s39, 20480
    buffer_load_dwordx4 v[124:127], v19, s[12:15], s39 offen
    s_mov_b32 s39, 24576
    buffer_load_dwordx4 v[128:131], v19, s[12:15], s39 offen
    v_lshlrev_b32 v248, 16, v108
    v_and_b32 v249, s38, v108
    v_lshlrev_b32 v250, 16, v109
    v_and_b32 v251, s38, v109
    v_lshlrev_b32 v252, 16, v110
    v_and_b32 v253, s38, v110
    v_lshlrev_b32 v254, 16, v111
    v_and_b32 v255, s38, v111
    v_pk_mul_f32 v[248:249], v[248:249], s[36:37]
    v_pk_mul_f32 v[250:251], v[250:251], s[36:37]
    v_pk_mul_f32 v[252:253], v[252:253], s[36:37]
    v_pk_mul_f32 v[254:255], v[254:255], s[36:37]
    v_cvt_pk_bf16_f32 v108, v248, v249
    v_cvt_pk_bf16_f32 v109, v250, v251
    v_cvt_pk_bf16_f32 v110, v252, v253
    v_cvt_pk_bf16_f32 v111, v254, v255
    ds_write_b128 v40, v[108:111] offset:4096
    s_waitcnt vmcnt(10)
    s_add_u32 m0, s34, 16384
    s_nop 0
    buffer_load_dwordx4 v8, s[20:23], s48 offen lds
    buffer_load_dwordx4 v8, s[20:23], s48 offen offset:1024 lds
    v_lshlrev_b32 v248, 16, v112
    v_and_b32 v249, s38, v112
    v_lshlrev_b32 v250, 16, v113
    v_and_b32 v251, s38, v113
    v_lshlrev_b32 v252, 16, v114
    v_and_b32 v253, s38, v114
    v_lshlrev_b32 v254, 16, v115
    v_and_b32 v255, s38, v115
    v_pk_mul_f32 v[248:249], v[248:249], s[36:37]
    v_pk_mul_f32 v[250:251], v[250:251], s[36:37]
    v_pk_mul_f32 v[252:253], v[252:253], s[36:37]
    v_pk_mul_f32 v[254:255], v[254:255], s[36:37]
    v_cvt_pk_bf16_f32 v112, v248, v249
    v_cvt_pk_bf16_f32 v113, v250, v251
    v_cvt_pk_bf16_f32 v114, v252, v253
    v_cvt_pk_bf16_f32 v115, v254, v255
    ds_write_b128 v40, v[112:115] offset:40960
    s_waitcnt vmcnt(5)
    v_lshlrev_b32 v248, 16, v116
    v_and_b32 v249, s38, v116
    v_lshlrev_b32 v250, 16, v117
    v_and_b32 v251, s38, v117
    v_lshlrev_b32 v252, 16, v118
    v_and_b32 v253, s38, v118
    v_lshlrev_b32 v254, 16, v119
    v_and_b32 v255, s38, v119
    v_pk_mul_f32 v[248:249], v[248:249], s[36:37]
    v_pk_mul_f32 v[250:251], v[250:251], s[36:37]
    v_pk_mul_f32 v[252:253], v[252:253], s[36:37]
    v_pk_mul_f32 v[254:255], v[254:255], s[36:37]
    v_cvt_pk_bf16_f32 v116, v248, v249
    v_cvt_pk_bf16_f32 v117, v250, v251
    v_cvt_pk_bf16_f32 v118, v252, v253
    v_cvt_pk_bf16_f32 v119, v254, v255
    ds_write_b128 v40, v[116:119] offset:45056
    s_waitcnt vmcnt(4)
    v_lshlrev_b32 v248, 16, v120
    v_and_b32 v249, s38, v120
    v_lshlrev_b32 v250, 16, v121
    v_and_b32 v251, s38, v121
    v_lshlrev_b32 v252, 16, v122
    v_and_b32 v253, s38, v122
    v_lshlrev_b32 v254, 16, v123
    v_and_b32 v255, s38, v123
    v_pk_mul_f32 v[248:249], v[248:249], s[36:37]
    v_pk_mul_f32 v[250:251], v[250:251], s[36:37]
    v_pk_mul_f32 v[252:253], v[252:253], s[36:37]
    v_pk_mul_f32 v[254:255], v[254:255], s[36:37]
    v_cvt_pk_bf16_f32 v120, v248, v249
    v_cvt_pk_bf16_f32 v121, v250, v251
    v_cvt_pk_bf16_f32 v122, v252, v253
    v_cvt_pk_bf16_f32 v123, v254, v255
    ds_write_b128 v41, v[120:123] offset:0
    s_waitcnt vmcnt(3)
    v_lshlrev_b32 v248, 16, v124
    v_and_b32 v249, s38, v124
    v_lshlrev_b32 v250, 16, v125
    v_and_b32 v251, s38, v125
    v_lshlrev_b32 v252, 16, v126
    v_and_b32 v253, s38, v126
    v_lshlrev_b32 v254, 16, v127
    v_and_b32 v255, s38, v127
    v_pk_mul_f32 v[248:249], v[248:249], s[36:37]
    v_pk_mul_f32 v[250:251], v[250:251], s[36:37]
    v_pk_mul_f32 v[252:253], v[252:253], s[36:37]
    v_pk_mul_f32 v[254:255], v[254:255], s[36:37]
    v_cvt_pk_bf16_f32 v124, v248, v249
    v_cvt_pk_bf16_f32 v125, v250, v251
    v_cvt_pk_bf16_f32 v126, v252, v253
    v_cvt_pk_bf16_f32 v127, v254, v255
    ds_write_b128 v41, v[124:127] offset:4096
    s_waitcnt vmcnt(2)
    v_lshlrev_b32 v248, 16, v128
    v_and_b32 v249, s38, v128
    v_lshlrev_b32 v250, 16, v129
    v_and_b32 v251, s38, v129
    v_lshlrev_b32 v252, 16, v130
    v_and_b32 v253, s38, v130
    v_lshlrev_b32 v254, 16, v131
    v_and_b32 v255, s38, v131
    v_pk_mul_f32 v[248:249], v[248:249], s[36:37]
    v_pk_mul_f32 v[250:251], v[250:251], s[36:37]
    v_pk_mul_f32 v[252:253], v[252:253], s[36:37]
    v_pk_mul_f32 v[254:255], v[254:255], s[36:37]
    v_cvt_pk_bf16_f32 v128, v248, v249
    v_cvt_pk_bf16_f32 v129, v250, v251
    v_cvt_pk_bf16_f32 v130, v252, v253
    v_cvt_pk_bf16_f32 v131, v254, v255
    ds_write_b128 v41, v[128:131] offset:40960
    s_waitcnt lgkmcnt(0)
    s_barrier
    ds_read_b128 v[136:139], v42 offset:0
    ds_read_b128 v[140:143], v42 offset:64
    ds_read_b128 v[144:147], v44 offset:0
    ds_read_b128 v[148:151], v44 offset:64
    ds_read_b128 a[168:171], v152 offset:0
    ds_read_b128 a[172:175], v153 offset:0
    ds_read_b128 a[176:179], v154 offset:0
    ds_read_b128 a[180:183], v155 offset:0
    s_add_u32 m0, s34, 18432
    s_nop 0
    buffer_load_dwordx4 v8, s[20:23], s49 offen lds
    buffer_load_dwordx4 v8, s[20:23], s49 offen offset:1024 lds
    s_waitcnt lgkmcnt(4)
    v_bitop3_b32 v136, v136, v43, s3 bitop3:0x28
    v_bitop3_b32 v137, v137, v43, s3 bitop3:0x28
    v_bitop3_b32 v138, v138, v43, s3 bitop3:0x28
    v_bitop3_b32 v139, v139, v43, s3 bitop3:0x28
    v_bitop3_b32 v140, v140, v43, s3 bitop3:0x28
    v_bitop3_b32 v141, v141, v43, s3 bitop3:0x28
    v_bitop3_b32 v142, v142, v43, s3 bitop3:0x28
    v_bitop3_b32 v143, v143, v43, s3 bitop3:0x28
    v_bitop3_b32 v144, v144, v43, s3 bitop3:0x28
    v_bitop3_b32 v145, v145, v43, s3 bitop3:0x28
    v_bitop3_b32 v146, v146, v43, s3 bitop3:0x28
    v_bitop3_b32 v147, v147, v43, s3 bitop3:0x28
    v_bitop3_b32 v148, v148, v43, s3 bitop3:0x28
    v_bitop3_b32 v149, v149, v43, s3 bitop3:0x28
    v_bitop3_b32 v150, v150, v43, s3 bitop3:0x28
    v_bitop3_b32 v151, v151, v43, s3 bitop3:0x28
    ds_read_b128 v[160:163], v9 offset:0
    ds_read_b128 v[164:167], v10 offset:0
    ds_read_b128 v[168:171], v11 offset:0
    ds_read_b128 v[172:175], v12 offset:0
    ds_read_b128 v[176:179], v9 offset:4096
    ds_read_b128 v[180:183], v10 offset:4096
    ds_read_b128 v[184:187], v11 offset:4096
    ds_read_b128 v[188:191], v12 offset:4096
    s_waitcnt lgkmcnt(8)
    v_mfma_f32_16x16x32_bf16 v[48:51], v[136:139], a[168:171], v[48:51]
    ds_read_b128 a[184:187], v152 offset:4096
    v_mfma_f32_16x16x32_bf16 v[48:51], v[140:143], a[172:175], v[48:51]
    ds_read_b128 a[188:191], v153 offset:4096
    v_mfma_f32_16x16x32_bf16 v[48:51], v[144:147], a[176:179], v[48:51]
    ds_read_b128 a[192:195], v154 offset:4096
    v_mfma_f32_16x16x32_bf16 v[48:51], v[148:151], a[180:183], v[48:51]
    s_waitcnt lgkmcnt(7)
    v_mfma_f32_16x16x32_bf16 v[24:27], v[160:163], a[168:171], v[48:51]
    ds_read_b128 a[196:199], v155 offset:4096
    v_mfma_f32_16x16x32_bf16 v[24:27], v[164:167], a[172:175], v[24:27]
    s_nop 0
    v_mfma_f32_16x16x32_bf16 v[24:27], v[168:171], a[176:179], v[24:27]
    s_nop 0
    v_mfma_f32_16x16x32_bf16 v[24:27], v[172:175], a[180:183], v[24:27]
    s_waitcnt lgkmcnt(4)
    v_mfma_f32_16x16x32_bf16 v[28:31], v[176:179], a[168:171], v[48:51]
    s_add_u32 m0, s34, 20480
    s_nop 0
    buffer_load_dwordx4 v8, s[20:23], s50 offen lds
    v_mfma_f32_16x16x32_bf16 v[28:31], v[180:183], a[172:175], v[28:31]
    buffer_load_dwordx4 v8, s[20:23], s50 offen offset:1024 lds
    v_mfma_f32_16x16x32_bf16 v[28:31], v[184:187], a[176:179], v[28:31]
    buffer_load_dwordx4 v8, s[20:23], s50 offen offset:2048 lds
    v_mfma_f32_16x16x32_bf16 v[28:31], v[188:191], a[180:183], v[28:31]
    buffer_load_dwordx4 v8, s[20:23], s50 offen offset:3072 lds
    s_waitcnt lgkmcnt(0)
    v_mfma_f32_16x16x32_bf16 v[52:55], v[136:139], a[184:187], v[52:55]
    ds_read_b128 a[200:203], v152 offset:40960
    s_add_u32 m0, s34, 8192
    s_nop 0
    buffer_load_dwordx4 v4, s[16:19], s52 offen lds
    v_mfma_f32_16x16x32_bf16 v[52:55], v[140:143], a[188:191], v[52:55]
    v_exp_f32 v24, v24
    v_mfma_f32_16x16x32_bf16 v[52:55], v[144:147], a[192:195], v[52:55]
    v_exp_f32 v25, v25
    v_mfma_f32_16x16x32_bf16 v[52:55], v[148:151], a[196:199], v[52:55]
    ds_read_b128 a[204:207], v153 offset:40960
    buffer_load_dwordx4 v5, s[16:19], s52 offen offset:1024 lds
    v_cvt_pk_bf16_f32 v80, v24, v25
    v_mfma_f32_16x16x32_bf16 v[32:35], v[160:163], a[184:187], v[52:55]
    v_exp_f32 v26, v26
    v_mfma_f32_16x16x32_bf16 v[32:35], v[164:167], a[188:191], v[32:35]
    v_exp_f32 v27, v27
    v_mfma_f32_16x16x32_bf16 v[32:35], v[168:171], a[192:195], v[32:35]
    ds_read_b128 a[208:211], v154 offset:40960
    ds_read_b128 a[212:215], v155 offset:40960
    v_cvt_pk_bf16_f32 v81, v26, v27
    v_mfma_f32_16x16x32_bf16 v[32:35], v[172:175], a[196:199], v[32:35]
    v_exp_f32 v28, v28
    v_mfma_f32_16x16x32_bf16 v[36:39], v[176:179], a[184:187], v[52:55]
    v_exp_f32 v29, v29
    v_mfma_f32_16x16x32_bf16 v[36:39], v[180:183], a[188:191], v[36:39]
    v_cvt_pk_bf16_f32 v82, v28, v29
    v_mfma_f32_16x16x32_bf16 v[36:39], v[184:187], a[192:195], v[36:39]
    v_exp_f32 v30, v30
    v_mfma_f32_16x16x32_bf16 v[36:39], v[188:191], a[196:199], v[36:39]
    v_exp_f32 v31, v31
    s_nop 0
    v_cvt_pk_bf16_f32 v83, v30, v31
    s_waitcnt lgkmcnt(0)
    v_mfma_f32_16x16x32_bf16 v[56:59], v[136:139], a[200:203], v[56:59]
    ds_read_b128 a[216:219], v152 offset:45056
    s_add_u32 m0, s34, 24576
    s_nop 0
    buffer_load_dwordx4 v8, s[20:23], s52 offen lds
    v_mfma_f32_16x16x32_bf16 v[56:59], v[140:143], a[204:207], v[56:59]
    v_exp_f32 v32, v32
    v_mfma_f32_16x16x32_bf16 v[56:59], v[144:147], a[208:211], v[56:59]
    v_exp_f32 v33, v33
    v_mfma_f32_16x16x32_bf16 v[56:59], v[148:151], a[212:215], v[56:59]
    ds_read_b128 a[220:223], v153 offset:45056
    buffer_load_dwordx4 v8, s[20:23], s52 offen offset:1024 lds
    v_cvt_pk_bf16_f32 v84, v32, v33
    v_mfma_f32_16x16x32_bf16 v[24:27], v[160:163], a[200:203], v[56:59]
    v_exp_f32 v34, v34
    v_mfma_f32_16x16x32_bf16 v[24:27], v[164:167], a[204:207], v[24:27]
    v_exp_f32 v35, v35
    v_mfma_f32_16x16x32_bf16 v[24:27], v[168:171], a[208:211], v[24:27]
    ds_read_b128 a[224:227], v154 offset:45056
    ds_read_b128 a[228:231], v155 offset:45056
    v_cvt_pk_bf16_f32 v85, v34, v35
    v_mfma_f32_16x16x32_bf16 v[24:27], v[172:175], a[212:215], v[24:27]
    v_exp_f32 v36, v36
    v_mfma_f32_16x16x32_bf16 v[28:31], v[176:179], a[200:203], v[56:59]
    v_exp_f32 v37, v37
    v_mfma_f32_16x16x32_bf16 v[28:31], v[180:183], a[204:207], v[28:31]
    v_cvt_pk_bf16_f32 v86, v36, v37
    v_mfma_f32_16x16x32_bf16 v[28:31], v[184:187], a[208:211], v[28:31]
    v_exp_f32 v38, v38
    v_mfma_f32_16x16x32_bf16 v[28:31], v[188:191], a[212:215], v[28:31]
    v_exp_f32 v39, v39
    s_nop 0
    v_cvt_pk_bf16_f32 v87, v38, v39
    s_waitcnt lgkmcnt(0)
    v_mfma_f32_16x16x32_bf16 v[60:63], v[136:139], a[216:219], v[60:63]
    ds_read_b128 a[232:235], v156 offset:0
    s_add_u32 m0, s34, 10240
    s_nop 0
    buffer_load_dwordx4 v6, s[16:19], s53 offen lds
    v_mfma_f32_16x16x32_bf16 v[60:63], v[140:143], a[220:223], v[60:63]
    v_exp_f32 v24, v24
    v_mfma_f32_16x16x32_bf16 v[60:63], v[144:147], a[224:227], v[60:63]
    v_exp_f32 v25, v25
    v_mfma_f32_16x16x32_bf16 v[60:63], v[148:151], a[228:231], v[60:63]
    ds_read_b128 a[236:239], v157 offset:0
    buffer_load_dwordx4 v7, s[16:19], s53 offen offset:1024 lds
    v_cvt_pk_bf16_f32 v88, v24, v25
    v_mfma_f32_16x16x32_bf16 v[32:35], v[160:163], a[216:219], v[60:63]
    v_exp_f32 v26, v26
    v_mfma_f32_16x16x32_bf16 v[32:35], v[164:167], a[220:223], v[32:35]
    v_exp_f32 v27, v27
    v_mfma_f32_16x16x32_bf16 v[32:35], v[168:171], a[224:227], v[32:35]
    ds_read_b128 a[240:243], v158 offset:0
    ds_read_b128 a[244:247], v159 offset:0
    v_cvt_pk_bf16_f32 v89, v26, v27
    v_mfma_f32_16x16x32_bf16 v[32:35], v[172:175], a[228:231], v[32:35]
    v_exp_f32 v28, v28
    v_mfma_f32_16x16x32_bf16 v[36:39], v[176:179], a[216:219], v[60:63]
    v_exp_f32 v29, v29
    v_mfma_f32_16x16x32_bf16 v[36:39], v[180:183], a[220:223], v[36:39]
    v_cvt_pk_bf16_f32 v90, v28, v29
    v_mfma_f32_16x16x32_bf16 v[36:39], v[184:187], a[224:227], v[36:39]
    v_exp_f32 v30, v30
    v_mfma_f32_16x16x32_bf16 v[36:39], v[188:191], a[228:231], v[36:39]
    v_exp_f32 v31, v31
    s_nop 0
    v_cvt_pk_bf16_f32 v91, v30, v31
    s_waitcnt lgkmcnt(0)
    v_mfma_f32_16x16x32_bf16 v[64:67], v[136:139], a[232:235], v[64:67]
    ds_read_b128 a[248:251], v156 offset:4096
    s_add_u32 m0, s34, 12288
    s_nop 0
    buffer_load_dwordx4 v4, s[16:19], s54 offen lds
    v_mfma_f32_16x16x32_bf16 v[64:67], v[140:143], a[236:239], v[64:67]
    v_exp_f32 v32, v32
    v_mfma_f32_16x16x32_bf16 v[64:67], v[144:147], a[240:243], v[64:67]
    v_exp_f32 v33, v33
    v_mfma_f32_16x16x32_bf16 v[64:67], v[148:151], a[244:247], v[64:67]
    ds_read_b128 a[252:255], v157 offset:4096
    buffer_load_dwordx4 v5, s[16:19], s54 offen offset:1024 lds
    v_cvt_pk_bf16_f32 v92, v32, v33
    v_mfma_f32_16x16x32_bf16 v[24:27], v[160:163], a[232:235], v[64:67]
    v_exp_f32 v34, v34
    v_mfma_f32_16x16x32_bf16 v[24:27], v[164:167], a[236:239], v[24:27]
    v_exp_f32 v35, v35
    v_mfma_f32_16x16x32_bf16 v[24:27], v[168:171], a[240:243], v[24:27]
    ds_read_b128 v[224:227], v158 offset:4096
    ds_read_b128 v[228:231], v159 offset:4096
    v_cvt_pk_bf16_f32 v93, v34, v35
    v_mfma_f32_16x16x32_bf16 v[24:27], v[172:175], a[244:247], v[24:27]
    v_exp_f32 v36, v36
    v_mfma_f32_16x16x32_bf16 v[28:31], v[176:179], a[232:235], v[64:67]
    v_exp_f32 v37, v37
    v_mfma_f32_16x16x32_bf16 v[28:31], v[180:183], a[236:239], v[28:31]
    v_cvt_pk_bf16_f32 v94, v36, v37
    v_mfma_f32_16x16x32_bf16 v[28:31], v[184:187], a[240:243], v[28:31]
    v_exp_f32 v38, v38
    v_mfma_f32_16x16x32_bf16 v[28:31], v[188:191], a[244:247], v[28:31]
    v_exp_f32 v39, v39
    s_nop 0
    v_cvt_pk_bf16_f32 v95, v38, v39
    s_waitcnt lgkmcnt(0)
    v_mfma_f32_16x16x32_bf16 v[68:71], v[136:139], a[248:251], v[68:71]
    ds_read_b128 v[232:235], v156 offset:40960
    buffer_load_dwordx4 v6, s[16:19], s54 offen offset:2048 lds
    v_mfma_f32_16x16x32_bf16 v[68:71], v[140:143], a[252:255], v[68:71]
    v_exp_f32 v24, v24
    v_mfma_f32_16x16x32_bf16 v[68:71], v[144:147], v[224:227], v[68:71]
    v_exp_f32 v25, v25
    v_mfma_f32_16x16x32_bf16 v[68:71], v[148:151], v[228:231], v[68:71]
    ds_read_b128 v[236:239], v157 offset:40960
    buffer_load_dwordx4 v7, s[16:19], s54 offen offset:3072 lds
    v_cvt_pk_bf16_f32 v96, v24, v25
    v_mfma_f32_16x16x32_bf16 v[32:35], v[160:163], a[248:251], v[68:71]
    v_exp_f32 v26, v26
    v_mfma_f32_16x16x32_bf16 v[32:35], v[164:167], a[252:255], v[32:35]
    v_exp_f32 v27, v27
    v_mfma_f32_16x16x32_bf16 v[32:35], v[168:171], v[224:227], v[32:35]
    ds_read_b128 v[240:243], v158 offset:40960
    ds_read_b128 v[244:247], v159 offset:40960
    v_cvt_pk_bf16_f32 v97, v26, v27
    v_mfma_f32_16x16x32_bf16 v[32:35], v[172:175], v[228:231], v[32:35]
    v_exp_f32 v28, v28
    v_mfma_f32_16x16x32_bf16 v[36:39], v[176:179], a[248:251], v[68:71]
    v_exp_f32 v29, v29
    v_mfma_f32_16x16x32_bf16 v[36:39], v[180:183], a[252:255], v[36:39]
    v_cvt_pk_bf16_f32 v98, v28, v29
    v_mfma_f32_16x16x32_bf16 v[36:39], v[184:187], v[224:227], v[36:39]
    v_exp_f32 v30, v30
    v_mfma_f32_16x16x32_bf16 v[36:39], v[188:191], v[228:231], v[36:39]
    v_exp_f32 v31, v31
    s_nop 0
    v_cvt_pk_bf16_f32 v99, v30, v31
    s_waitcnt lgkmcnt(0)
    s_waitcnt vmcnt(10)
    v_mfma_f32_16x16x32_bf16 v[72:75], v[136:139], v[232:235], v[72:75]
    ds_read_b64_tr_b16 v[192:193], v13 offset:0
    ds_read_b64_tr_b16 v[194:195], v13 offset:4096
    ds_read_b64_tr_b16 v[196:197], v13 offset:8
    ds_read_b64_tr_b16 v[198:199], v13 offset:4104
    v_mfma_f32_16x16x32_bf16 v[72:75], v[140:143], v[236:239], v[72:75]
    v_exp_f32 v32, v32
    v_mfma_f32_16x16x32_bf16 v[72:75], v[144:147], v[240:243], v[72:75]
    v_exp_f32 v33, v33
    v_mfma_f32_16x16x32_bf16 v[72:75], v[148:151], v[244:247], v[72:75]
    ds_read_b64_tr_b16 v[200:201], v14 offset:0
    ds_read_b64_tr_b16 v[202:203], v14 offset:4096
    ds_read_b64_tr_b16 v[204:205], v14 offset:8
    ds_read_b64_tr_b16 v[206:207], v14 offset:4104
    v_cvt_pk_bf16_f32 v100, v32, v33
    v_mfma_f32_16x16x32_bf16 v[24:27], v[160:163], v[232:235], v[72:75]
    v_exp_f32 v34, v34
    v_mfma_f32_16x16x32_bf16 v[24:27], v[164:167], v[236:239], v[24:27]
    v_exp_f32 v35, v35
    v_mfma_f32_16x16x32_bf16 v[24:27], v[168:171], v[240:243], v[24:27]
    ds_read_b64_tr_b16 v[208:209], v15 offset:0
    ds_read_b64_tr_b16 v[210:211], v15 offset:4096
    ds_read_b64_tr_b16 v[212:213], v15 offset:8
    ds_read_b64_tr_b16 v[214:215], v15 offset:4104
    v_cvt_pk_bf16_f32 v101, v34, v35
    v_mfma_f32_16x16x32_bf16 v[24:27], v[172:175], v[244:247], v[24:27]
    v_exp_f32 v36, v36
    v_mfma_f32_16x16x32_bf16 v[28:31], v[176:179], v[232:235], v[72:75]
    v_exp_f32 v37, v37
    v_mfma_f32_16x16x32_bf16 v[28:31], v[180:183], v[236:239], v[28:31]
    ds_read_b64_tr_b16 v[248:249], v16 offset:0
    ds_read_b64_tr_b16 v[250:251], v16 offset:4096
    ds_read_b64_tr_b16 v[252:253], v16 offset:8
    ds_read_b64_tr_b16 v[254:255], v16 offset:4104
    v_cvt_pk_bf16_f32 v102, v36, v37
    v_mfma_f32_16x16x32_bf16 v[28:31], v[184:187], v[240:243], v[28:31]
    v_exp_f32 v38, v38
    v_mfma_f32_16x16x32_bf16 v[28:31], v[188:191], v[244:247], v[28:31]
    v_exp_f32 v39, v39
    s_nop 0
    v_cvt_pk_bf16_f32 v103, v38, v39
    s_waitcnt lgkmcnt(8)
    v_mfma_f32_16x16x32_bf16 v[104:107], v[192:195], v[80:83], 0
    v_mfma_f32_16x16x32_bf16 v[108:111], v[196:199], v[80:83], 0
    v_mfma_f32_16x16x32_bf16 a[0:3], v[200:203], v[80:83], 0
    v_exp_f32 v24, v24
    v_mfma_f32_16x16x32_bf16 a[4:7], v[204:207], v[80:83], 0
    s_add_u32 m0, s34, 26624
    s_waitcnt lgkmcnt(0)
    v_mfma_f32_16x16x32_bf16 a[8:11], v[208:211], v[80:83], 0
    v_exp_f32 v25, v25
    v_mfma_f32_16x16x32_bf16 a[12:15], v[212:215], v[80:83], 0
    buffer_load_dwordx4 v8, s[20:23], s53 offen lds
    v_mfma_f32_16x16x32_bf16 a[16:19], v[248:251], v[80:83], 0
    v_exp_f32 v26, v26
    v_mfma_f32_16x16x32_bf16 a[20:23], v[252:255], v[80:83], 0
    v_mfma_f32_16x16x32_bf16 v[76:79], v[20:23], v[80:83], 0
    v_exp_f32 v27, v27
    v_mfma_f32_16x16x32_bf16 v[112:115], v[192:195], v[84:87], 0
    v_mfma_f32_16x16x32_bf16 v[116:119], v[196:199], v[84:87], 0
    v_cvt_pk_bf16_f32 v40, v24, v25
    v_cvt_pk_bf16_f32 v41, v26, v27
    v_mfma_f32_16x16x32_bf16 a[24:27], v[200:203], v[84:87], 0
    s_barrier
    v_mfma_f32_16x16x32_bf16 a[28:31], v[204:207], v[84:87], 0
    v_exp_f32 v28, v28
    v_mfma_f32_16x16x32_bf16 a[32:35], v[208:211], v[84:87], 0
    buffer_load_dwordx4 v8, s[20:23], s53 offen offset:1024 lds
    v_mfma_f32_16x16x32_bf16 a[36:39], v[212:215], v[84:87], 0
    v_exp_f32 v29, v29
    v_mfma_f32_16x16x32_bf16 a[40:43], v[248:251], v[84:87], 0
    v_mfma_f32_16x16x32_bf16 a[44:47], v[252:255], v[84:87], 0
    v_exp_f32 v30, v30
    v_mfma_f32_16x16x32_bf16 v[80:83], v[20:23], v[84:87], 0
    v_mfma_f32_16x16x32_bf16 v[120:123], v[192:195], v[88:91], 0
    v_exp_f32 v31, v31
    v_mfma_f32_16x16x32_bf16 v[124:127], v[196:199], v[88:91], 0
    s_add_u32 m0, s34, 28672
    v_mfma_f32_16x16x32_bf16 a[48:51], v[200:203], v[88:91], 0
    v_cvt_pk_bf16_f32 v42, v28, v29
    v_cvt_pk_bf16_f32 v43, v30, v31
    v_mfma_f32_16x16x32_bf16 a[52:55], v[204:207], v[88:91], 0
    buffer_load_dwordx4 v8, s[20:23], s54 offen lds
    v_mfma_f32_16x16x32_bf16 a[56:59], v[208:211], v[88:91], 0
    v_mfma_f32_16x16x32_bf16 a[60:63], v[212:215], v[88:91], 0
    v_mfma_f32_16x16x32_bf16 a[64:67], v[248:251], v[88:91], 0
    buffer_load_dwordx4 v8, s[20:23], s54 offen offset:1024 lds
    v_mfma_f32_16x16x32_bf16 a[68:71], v[252:255], v[88:91], 0
    v_mfma_f32_16x16x32_bf16 v[84:87], v[20:23], v[88:91], 0
    v_mfma_f32_16x16x32_bf16 v[128:131], v[192:195], v[92:95], 0
    v_mfma_f32_16x16x32_bf16 v[132:135], v[196:199], v[92:95], 0
    buffer_load_dwordx4 v8, s[20:23], s54 offen offset:2048 lds
    v_mfma_f32_16x16x32_bf16 a[72:75], v[200:203], v[92:95], 0
    v_mfma_f32_16x16x32_bf16 a[76:79], v[204:207], v[92:95], 0
    v_mfma_f32_16x16x32_bf16 a[80:83], v[208:211], v[92:95], 0
    v_mfma_f32_16x16x32_bf16 a[84:87], v[212:215], v[92:95], 0
    buffer_load_dwordx4 v8, s[20:23], s54 offen offset:3072 lds
    v_mfma_f32_16x16x32_bf16 a[88:91], v[248:251], v[92:95], 0
    s_add_u32 m0, s34, 0
    v_mfma_f32_16x16x32_bf16 a[92:95], v[252:255], v[92:95], 0
    v_mfma_f32_16x16x32_bf16 v[88:91], v[20:23], v[92:95], 0
    buffer_load_dwordx4 v4, s[16:19], s56 offen lds
    v_mfma_f32_16x16x32_bf16 v[136:139], v[192:195], v[96:99], 0
    v_mfma_f32_16x16x32_bf16 v[140:143], v[196:199], v[96:99], 0
    v_mfma_f32_16x16x32_bf16 a[96:99], v[200:203], v[96:99], 0
    v_mfma_f32_16x16x32_bf16 a[100:103], v[204:207], v[96:99], 0
    buffer_load_dwordx4 v5, s[16:19], s56 offen offset:1024 lds
    v_mfma_f32_16x16x32_bf16 a[104:107], v[208:211], v[96:99], 0
    s_add_u32 m0, s34, 16384
    v_mfma_f32_16x16x32_bf16 a[108:111], v[212:215], v[96:99], 0
    v_mfma_f32_16x16x32_bf16 a[112:115], v[248:251], v[96:99], 0
    buffer_load_dwordx4 v8, s[20:23], s56 offen lds
    v_mfma_f32_16x16x32_bf16 a[116:119], v[252:255], v[96:99], 0
    v_mfma_f32_16x16x32_bf16 v[92:95], v[20:23], v[96:99], 0
    s_waitcnt vmcnt(9)
    v_mfma_f32_16x16x32_bf16 v[144:147], v[192:195], v[100:103], 0
    ds_read_b128 v[160:163], v9 offset:8192
    ds_read_b128 v[164:167], v10 offset:8192
    v_mfma_f32_16x16x32_bf16 v[148:151], v[196:199], v[100:103], 0
    ds_read_b128 v[168:171], v11 offset:8192
    ds_read_b128 v[172:175], v12 offset:8192
    v_mfma_f32_16x16x32_bf16 a[120:123], v[200:203], v[100:103], 0
    ds_read_b128 v[176:179], v9 offset:12288
    ds_read_b128 v[180:183], v10 offset:12288
    v_mfma_f32_16x16x32_bf16 a[124:127], v[204:207], v[100:103], 0
    ds_read_b128 v[184:187], v11 offset:12288
    ds_read_b128 v[188:191], v12 offset:12288
    v_mfma_f32_16x16x32_bf16 a[128:131], v[208:211], v[100:103], 0
    v_mfma_f32_16x16x32_bf16 a[132:135], v[212:215], v[100:103], 0
    v_mfma_f32_16x16x32_bf16 a[136:139], v[248:251], v[100:103], 0
    buffer_load_dwordx4 v8, s[20:23], s56 offen offset:1024 lds
    v_mfma_f32_16x16x32_bf16 a[140:143], v[252:255], v[100:103], 0
    v_mfma_f32_16x16x32_bf16 v[96:99], v[20:23], v[100:103], 0
    s_waitcnt lgkmcnt(0)
    v_mfma_f32_16x16x32_bf16 v[32:35], v[160:163], a[168:171], v[48:51]
    v_mfma_f32_16x16x32_bf16 v[32:35], v[164:167], a[172:175], v[32:35]
    v_mfma_f32_16x16x32_bf16 v[32:35], v[168:171], a[176:179], v[32:35]
    v_mfma_f32_16x16x32_bf16 v[32:35], v[172:175], a[180:183], v[32:35]
    v_mfma_f32_16x16x32_bf16 v[36:39], v[176:179], a[168:171], v[48:51]
    s_waitcnt vmcnt(4)
    s_add_u32 m0, s34, 2048
    v_mfma_f32_16x16x32_bf16 v[36:39], v[180:183], a[172:175], v[36:39]
    ds_read_b64_tr_b16 v[216:217], v16 offset:8192
    ds_read_b64_tr_b16 v[218:219], v16 offset:12288
    v_mfma_f32_16x16x32_bf16 v[36:39], v[184:187], a[176:179], v[36:39]
    ds_read_b64_tr_b16 v[220:221], v16 offset:8200
    ds_read_b64_tr_b16 v[222:223], v16 offset:12296
    v_mfma_f32_16x16x32_bf16 v[36:39], v[188:191], a[180:183], v[36:39]
    v_exp_f32 v32, v32
    v_mfma_f32_16x16x32_bf16 v[152:155], v[192:195], v[40:43], 0
    ds_read_b64_tr_b16 v[192:193], v13 offset:8192
    ds_read_b64_tr_b16 v[194:195], v13 offset:12288
    v_mfma_f32_16x16x32_bf16 v[156:159], v[196:199], v[40:43], 0
    v_exp_f32 v33, v33
    v_mfma_f32_16x16x32_bf16 a[144:147], v[200:203], v[40:43], 0
    ds_read_b64_tr_b16 v[196:197], v13 offset:8200
    v_cvt_pk_bf16_f32 v44, v32, v33
    v_mfma_f32_16x16x32_bf16 a[148:151], v[204:207], v[40:43], 0
    v_exp_f32 v34, v34
    v_mfma_f32_16x16x32_bf16 a[152:155], v[208:211], v[40:43], 0
    ds_read_b64_tr_b16 v[198:199], v13 offset:12296
    ds_read_b64_tr_b16 v[200:201], v14 offset:8192
    v_mfma_f32_16x16x32_bf16 a[156:159], v[212:215], v[40:43], 0
    v_exp_f32 v35, v35
    v_mfma_f32_16x16x32_bf16 a[160:163], v[248:251], v[40:43], 0
    ds_read_b64_tr_b16 v[202:203], v14 offset:12288
    v_cvt_pk_bf16_f32 v45, v34, v35
    v_mfma_f32_16x16x32_bf16 a[164:167], v[252:255], v[40:43], 0
    v_exp_f32 v36, v36
    v_mfma_f32_16x16x32_bf16 v[100:103], v[20:23], v[40:43], 0
    ds_read_b64_tr_b16 v[204:205], v14 offset:8200
    ds_read_b64_tr_b16 v[206:207], v14 offset:12296
    v_mfma_f32_16x16x32_bf16 v[24:27], v[160:163], a[184:187], v[52:55]
    v_exp_f32 v37, v37
    v_mfma_f32_16x16x32_bf16 v[24:27], v[164:167], a[188:191], v[24:27]
    ds_read_b64_tr_b16 v[208:209], v15 offset:8192
    v_cvt_pk_bf16_f32 v46, v36, v37
    v_mfma_f32_16x16x32_bf16 v[24:27], v[168:171], a[192:195], v[24:27]
    v_exp_f32 v38, v38
    v_mfma_f32_16x16x32_bf16 v[24:27], v[172:175], a[196:199], v[24:27]
    ds_read_b64_tr_b16 v[210:211], v15 offset:12288
    ds_read_b64_tr_b16 v[212:213], v15 offset:8200
    v_mfma_f32_16x16x32_bf16 v[28:31], v[176:179], a[184:187], v[52:55]
    v_exp_f32 v39, v39
    v_mfma_f32_16x16x32_bf16 v[28:31], v[180:183], a[188:191], v[28:31]
    ds_read_b64_tr_b16 v[214:215], v15 offset:12296
    v_cvt_pk_bf16_f32 v47, v38, v39
    v_mfma_f32_16x16x32_bf16 v[28:31], v[184:187], a[192:195], v[28:31]
    s_waitcnt lgkmcnt(6)
    v_mfma_f32_16x16x32_bf16 v[28:31], v[188:191], a[196:199], v[28:31]
    v_exp_f32 v24, v24
    v_mfma_f32_16x16x32_bf16 v[104:107], v[192:195], v[44:47], v[104:107]
    buffer_load_dwordx4 v6, s[16:19], s57 offen lds
    v_mfma_f32_16x16x32_bf16 v[108:111], v[196:199], v[44:47], v[108:111]
    v_exp_f32 v25, v25
    v_mfma_f32_16x16x32_bf16 a[0:3], v[200:203], v[44:47], a[0:3]
    s_waitcnt lgkmcnt(0)
    v_cvt_pk_bf16_f32 v40, v24, v25
    v_mfma_f32_16x16x32_bf16 a[4:7], v[204:207], v[44:47], a[4:7]
    v_exp_f32 v26, v26
    v_mfma_f32_16x16x32_bf16 a[8:11], v[208:211], v[44:47], a[8:11]
    buffer_load_dwordx4 v7, s[16:19], s57 offen offset:1024 lds
    v_mfma_f32_16x16x32_bf16 a[12:15], v[212:215], v[44:47], a[12:15]
    v_exp_f32 v27, v27
    v_mfma_f32_16x16x32_bf16 a[16:19], v[216:219], v[44:47], a[16:19]
    s_add_u32 m0, s34, 4096
    v_cvt_pk_bf16_f32 v41, v26, v27
    v_mfma_f32_16x16x32_bf16 a[20:23], v[220:223], v[44:47], a[20:23]
    v_exp_f32 v28, v28
    v_mfma_f32_16x16x32_bf16 v[76:79], v[20:23], v[44:47], v[76:79]
    buffer_load_dwordx4 v4, s[16:19], s58 offen lds
    v_mfma_f32_16x16x32_bf16 v[32:35], v[160:163], a[200:203], v[56:59]
    v_exp_f32 v29, v29
    v_mfma_f32_16x16x32_bf16 v[32:35], v[164:167], a[204:207], v[32:35]
    v_cvt_pk_bf16_f32 v42, v28, v29
    v_mfma_f32_16x16x32_bf16 v[32:35], v[168:171], a[208:211], v[32:35]
    v_exp_f32 v30, v30
    v_mfma_f32_16x16x32_bf16 v[32:35], v[172:175], a[212:215], v[32:35]
    buffer_load_dwordx4 v5, s[16:19], s58 offen offset:1024 lds
    v_mfma_f32_16x16x32_bf16 v[36:39], v[176:179], a[200:203], v[56:59]
    v_exp_f32 v31, v31
    v_mfma_f32_16x16x32_bf16 v[36:39], v[180:183], a[204:207], v[36:39]
    v_cvt_pk_bf16_f32 v43, v30, v31
    v_mfma_f32_16x16x32_bf16 v[36:39], v[184:187], a[208:211], v[36:39]
    buffer_load_dwordx4 v6, s[16:19], s58 offen offset:2048 lds
    v_mfma_f32_16x16x32_bf16 v[36:39], v[188:191], a[212:215], v[36:39]
    v_exp_f32 v32, v32
    v_mfma_f32_16x16x32_bf16 v[112:115], v[192:195], v[40:43], v[112:115]
    buffer_load_dwordx4 v7, s[16:19], s58 offen offset:3072 lds
    v_mfma_f32_16x16x32_bf16 v[116:119], v[196:199], v[40:43], v[116:119]
    v_exp_f32 v33, v33
    v_mfma_f32_16x16x32_bf16 a[24:27], v[200:203], v[40:43], a[24:27]
    s_add_u32 m0, s34, 18432
    v_cvt_pk_bf16_f32 v44, v32, v33
    v_mfma_f32_16x16x32_bf16 a[28:31], v[204:207], v[40:43], a[28:31]
    v_exp_f32 v34, v34
    v_mfma_f32_16x16x32_bf16 a[32:35], v[208:211], v[40:43], a[32:35]
    buffer_load_dwordx4 v8, s[20:23], s57 offen lds
    v_mfma_f32_16x16x32_bf16 a[36:39], v[212:215], v[40:43], a[36:39]
    v_exp_f32 v35, v35
    v_mfma_f32_16x16x32_bf16 a[40:43], v[216:219], v[40:43], a[40:43]
    v_cvt_pk_bf16_f32 v45, v34, v35
    v_mfma_f32_16x16x32_bf16 a[44:47], v[220:223], v[40:43], a[44:47]
    v_exp_f32 v36, v36
    v_mfma_f32_16x16x32_bf16 v[80:83], v[20:23], v[40:43], v[80:83]
    buffer_load_dwordx4 v8, s[20:23], s57 offen offset:1024 lds
    v_mfma_f32_16x16x32_bf16 v[24:27], v[160:163], a[216:219], v[60:63]
    v_exp_f32 v37, v37
    v_mfma_f32_16x16x32_bf16 v[24:27], v[164:167], a[220:223], v[24:27]
    s_add_u32 m0, s34, 20480
    v_cvt_pk_bf16_f32 v46, v36, v37
    v_mfma_f32_16x16x32_bf16 v[24:27], v[168:171], a[224:227], v[24:27]
    v_exp_f32 v38, v38
    v_mfma_f32_16x16x32_bf16 v[24:27], v[172:175], a[228:231], v[24:27]
    buffer_load_dwordx4 v8, s[20:23], s58 offen lds
    v_mfma_f32_16x16x32_bf16 v[28:31], v[176:179], a[216:219], v[60:63]
    v_exp_f32 v39, v39
    v_mfma_f32_16x16x32_bf16 v[28:31], v[180:183], a[220:223], v[28:31]
    v_cvt_pk_bf16_f32 v47, v38, v39
    v_mfma_f32_16x16x32_bf16 v[28:31], v[184:187], a[224:227], v[28:31]
    buffer_load_dwordx4 v8, s[20:23], s58 offen offset:1024 lds
    v_mfma_f32_16x16x32_bf16 v[28:31], v[188:191], a[228:231], v[28:31]
    v_exp_f32 v24, v24
    v_mfma_f32_16x16x32_bf16 v[120:123], v[192:195], v[44:47], v[120:123]
    v_mfma_f32_16x16x32_bf16 v[124:127], v[196:199], v[44:47], v[124:127]
    v_exp_f32 v25, v25
    v_mfma_f32_16x16x32_bf16 a[48:51], v[200:203], v[44:47], a[48:51]
    v_cvt_pk_bf16_f32 v40, v24, v25
    v_mfma_f32_16x16x32_bf16 a[52:55], v[204:207], v[44:47], a[52:55]
    v_exp_f32 v26, v26
    v_mfma_f32_16x16x32_bf16 a[56:59], v[208:211], v[44:47], a[56:59]
    v_mfma_f32_16x16x32_bf16 a[60:63], v[212:215], v[44:47], a[60:63]
    v_exp_f32 v27, v27
    v_mfma_f32_16x16x32_bf16 a[64:67], v[216:219], v[44:47], a[64:67]
    v_cvt_pk_bf16_f32 v41, v26, v27
    v_mfma_f32_16x16x32_bf16 a[68:71], v[220:223], v[44:47], a[68:71]
    v_exp_f32 v28, v28
    v_mfma_f32_16x16x32_bf16 v[84:87], v[20:23], v[44:47], v[84:87]
    buffer_load_dwordx4 v8, s[20:23], s58 offen offset:2048 lds
    v_mfma_f32_16x16x32_bf16 v[32:35], v[160:163], a[232:235], v[64:67]
    v_exp_f32 v29, v29
    v_mfma_f32_16x16x32_bf16 v[32:35], v[164:167], a[236:239], v[32:35]
    v_cvt_pk_bf16_f32 v42, v28, v29
    v_mfma_f32_16x16x32_bf16 v[32:35], v[168:171], a[240:243], v[32:35]
    v_exp_f32 v30, v30
    v_mfma_f32_16x16x32_bf16 v[32:35], v[172:175], a[244:247], v[32:35]
    buffer_load_dwordx4 v8, s[20:23], s58 offen offset:3072 lds
    v_mfma_f32_16x16x32_bf16 v[36:39], v[176:179], a[232:235], v[64:67]
    v_exp_f32 v31, v31
    v_mfma_f32_16x16x32_bf16 v[36:39], v[180:183], a[236:239], v[36:39]
    s_nop 0
    v_cvt_pk_bf16_f32 v43, v30, v31
    v_mfma_f32_16x16x32_bf16 v[36:39], v[184:187], a[240:243], v[36:39]
    v_mfma_f32_16x16x32_bf16 v[36:39], v[188:191], a[244:247], v[36:39]
    v_exp_f32 v32, v32
    v_mfma_f32_16x16x32_bf16 v[128:131], v[192:195], v[40:43], v[128:131]
    v_mfma_f32_16x16x32_bf16 v[132:135], v[196:199], v[40:43], v[132:135]
    v_exp_f32 v33, v33
    v_mfma_f32_16x16x32_bf16 a[72:75], v[200:203], v[40:43], a[72:75]
    s_add_u32 m0, s34, 8192
    v_cvt_pk_bf16_f32 v44, v32, v33
    v_mfma_f32_16x16x32_bf16 a[76:79], v[204:207], v[40:43], a[76:79]
    v_exp_f32 v34, v34
    v_mfma_f32_16x16x32_bf16 a[80:83], v[208:211], v[40:43], a[80:83]
    v_mfma_f32_16x16x32_bf16 a[84:87], v[212:215], v[40:43], a[84:87]
    v_exp_f32 v35, v35
    v_mfma_f32_16x16x32_bf16 a[88:91], v[216:219], v[40:43], a[88:91]
    v_cvt_pk_bf16_f32 v45, v34, v35
    v_mfma_f32_16x16x32_bf16 a[92:95], v[220:223], v[40:43], a[92:95]
    v_exp_f32 v36, v36
    v_mfma_f32_16x16x32_bf16 v[88:91], v[20:23], v[40:43], v[88:91]
    buffer_load_dwordx4 v4, s[16:19], s60 offen lds
    v_mfma_f32_16x16x32_bf16 v[24:27], v[160:163], a[248:251], v[68:71]
    v_exp_f32 v37, v37
    v_mfma_f32_16x16x32_bf16 v[24:27], v[164:167], a[252:255], v[24:27]
    v_cvt_pk_bf16_f32 v46, v36, v37
    v_mfma_f32_16x16x32_bf16 v[24:27], v[168:171], v[224:227], v[24:27]
    v_exp_f32 v38, v38
    v_mfma_f32_16x16x32_bf16 v[24:27], v[172:175], v[228:231], v[24:27]
    buffer_load_dwordx4 v5, s[16:19], s60 offen offset:1024 lds
    v_mfma_f32_16x16x32_bf16 v[28:31], v[176:179], a[248:251], v[68:71]
    v_exp_f32 v39, v39
    v_mfma_f32_16x16x32_bf16 v[28:31], v[180:183], a[252:255], v[28:31]
    s_add_u32 m0, s34, 24576
    v_cvt_pk_bf16_f32 v47, v38, v39
    v_mfma_f32_16x16x32_bf16 v[28:31], v[184:187], v[224:227], v[28:31]
    buffer_load_dwordx4 v8, s[20:23], s60 offen lds
    v_mfma_f32_16x16x32_bf16 v[28:31], v[188:191], v[228:231], v[28:31]
    v_exp_f32 v24, v24
    v_mfma_f32_16x16x32_bf16 v[136:139], v[192:195], v[44:47], v[136:139]
    v_mfma_f32_16x16x32_bf16 v[140:143], v[196:199], v[44:47], v[140:143]
    v_exp_f32 v25, v25
    v_mfma_f32_16x16x32_bf16 a[96:99], v[200:203], v[44:47], a[96:99]
    v_cvt_pk_bf16_f32 v40, v24, v25
    v_mfma_f32_16x16x32_bf16 a[100:103], v[204:207], v[44:47], a[100:103]
    v_exp_f32 v26, v26
    v_mfma_f32_16x16x32_bf16 a[104:107], v[208:211], v[44:47], a[104:107]
    buffer_load_dwordx4 v8, s[20:23], s60 offen offset:1024 lds
    v_mfma_f32_16x16x32_bf16 a[108:111], v[212:215], v[44:47], a[108:111]
    v_exp_f32 v27, v27
    v_mfma_f32_16x16x32_bf16 a[112:115], v[216:219], v[44:47], a[112:115]
    v_cvt_pk_bf16_f32 v41, v26, v27
    v_mfma_f32_16x16x32_bf16 a[116:119], v[220:223], v[44:47], a[116:119]
    v_exp_f32 v28, v28
    v_mfma_f32_16x16x32_bf16 v[92:95], v[20:23], v[44:47], v[92:95]
    s_waitcnt vmcnt(10)
    v_mfma_f32_16x16x32_bf16 v[32:35], v[160:163], v[232:235], v[72:75]
    v_exp_f32 v29, v29
    v_mfma_f32_16x16x32_bf16 v[32:35], v[164:167], v[236:239], v[32:35]
    ds_read_b128 v[160:163], v9 offset:0
    v_cvt_pk_bf16_f32 v42, v28, v29
    v_mfma_f32_16x16x32_bf16 v[32:35], v[168:171], v[240:243], v[32:35]
    v_exp_f32 v30, v30
    v_mfma_f32_16x16x32_bf16 v[32:35], v[172:175], v[244:247], v[32:35]
    ds_read_b128 v[164:167], v10 offset:0
    ds_read_b128 v[168:171], v11 offset:0
    v_mfma_f32_16x16x32_bf16 v[36:39], v[176:179], v[232:235], v[72:75]
    v_exp_f32 v31, v31
    v_mfma_f32_16x16x32_bf16 v[36:39], v[180:183], v[236:239], v[36:39]
    ds_read_b128 v[172:175], v12 offset:0
    v_cvt_pk_bf16_f32 v43, v30, v31
    v_mfma_f32_16x16x32_bf16 v[36:39], v[184:187], v[240:243], v[36:39]
    ds_read_b128 v[176:179], v9 offset:4096
    ds_read_b128 v[180:183], v10 offset:4096
    v_mfma_f32_16x16x32_bf16 v[36:39], v[188:191], v[244:247], v[36:39]
    v_exp_f32 v32, v32
    v_mfma_f32_16x16x32_bf16 v[144:147], v[192:195], v[40:43], v[144:147]
    ds_read_b128 v[184:187], v11 offset:4096
    ds_read_b128 v[188:191], v12 offset:4096
    v_mfma_f32_16x16x32_bf16 v[148:151], v[196:199], v[40:43], v[148:151]
    v_exp_f32 v33, v33
    v_mfma_f32_16x16x32_bf16 a[120:123], v[200:203], v[40:43], a[120:123]
    s_add_u32 m0, s34, 10240
    v_cvt_pk_bf16_f32 v44, v32, v33
    v_mfma_f32_16x16x32_bf16 a[124:127], v[204:207], v[40:43], a[124:127]
    v_exp_f32 v34, v34
    v_mfma_f32_16x16x32_bf16 a[128:131], v[208:211], v[40:43], a[128:131]
    s_waitcnt vmcnt(4)
    v_mfma_f32_16x16x32_bf16 a[132:135], v[212:215], v[40:43], a[132:135]
    v_exp_f32 v35, v35
    v_mfma_f32_16x16x32_bf16 a[136:139], v[216:219], v[40:43], a[136:139]
    ds_read_b64_tr_b16 v[248:249], v16 offset:0
    v_cvt_pk_bf16_f32 v45, v34, v35
    v_mfma_f32_16x16x32_bf16 a[140:143], v[220:223], v[40:43], a[140:143]
    v_exp_f32 v36, v36
    v_mfma_f32_16x16x32_bf16 v[96:99], v[20:23], v[40:43], v[96:99]
    s_waitcnt lgkmcnt(1)
    ds_read_b64_tr_b16 v[250:251], v16 offset:4096
    v_mfma_f32_16x16x32_bf16 v[24:27], v[160:163], a[168:171], v[48:51]
    v_exp_f32 v37, v37
    v_mfma_f32_16x16x32_bf16 v[24:27], v[164:167], a[172:175], v[24:27]
    ds_read_b64_tr_b16 v[252:253], v16 offset:8
    v_cvt_pk_bf16_f32 v46, v36, v37
    v_mfma_f32_16x16x32_bf16 v[24:27], v[168:171], a[176:179], v[24:27]
    v_exp_f32 v38, v38
    v_mfma_f32_16x16x32_bf16 v[24:27], v[172:175], a[180:183], v[24:27]
    ds_read_b64_tr_b16 v[254:255], v16 offset:4104
    v_mfma_f32_16x16x32_bf16 v[28:31], v[176:179], a[168:171], v[48:51]
    v_exp_f32 v39, v39
    v_mfma_f32_16x16x32_bf16 v[28:31], v[180:183], a[172:175], v[28:31]
    v_cvt_pk_bf16_f32 v47, v38, v39
    v_mfma_f32_16x16x32_bf16 v[28:31], v[184:187], a[176:179], v[28:31]
    buffer_load_dwordx4 v6, s[16:19], s61 offen lds
    v_mfma_f32_16x16x32_bf16 v[28:31], v[188:191], a[180:183], v[28:31]
    v_exp_f32 v24, v24
    v_mfma_f32_16x16x32_bf16 v[152:155], v[192:195], v[44:47], v[152:155]
    ds_read_b64_tr_b16 v[192:193], v13 offset:0
    ds_read_b64_tr_b16 v[194:195], v13 offset:4096
    v_mfma_f32_16x16x32_bf16 v[156:159], v[196:199], v[44:47], v[156:159]
    v_exp_f32 v25, v25
    v_mfma_f32_16x16x32_bf16 a[144:147], v[200:203], v[44:47], a[144:147]
    ds_read_b64_tr_b16 v[196:197], v13 offset:8
    v_cvt_pk_bf16_f32 v40, v24, v25
    v_mfma_f32_16x16x32_bf16 a[148:151], v[204:207], v[44:47], a[148:151]
    v_exp_f32 v26, v26
    v_mfma_f32_16x16x32_bf16 a[152:155], v[208:211], v[44:47], a[152:155]
    ds_read_b64_tr_b16 v[198:199], v13 offset:4104
    ds_read_b64_tr_b16 v[200:201], v14 offset:0
    v_mfma_f32_16x16x32_bf16 a[156:159], v[212:215], v[44:47], a[156:159]
    v_exp_f32 v27, v27
    v_mfma_f32_16x16x32_bf16 a[160:163], v[216:219], v[44:47], a[160:163]
    ds_read_b64_tr_b16 v[202:203], v14 offset:4096
    v_cvt_pk_bf16_f32 v41, v26, v27
    v_mfma_f32_16x16x32_bf16 a[164:167], v[220:223], v[44:47], a[164:167]
    v_exp_f32 v28, v28
    v_mfma_f32_16x16x32_bf16 v[100:103], v[20:23], v[44:47], v[100:103]
    ds_read_b64_tr_b16 v[204:205], v14 offset:8
    ds_read_b64_tr_b16 v[206:207], v14 offset:4104
    v_mfma_f32_16x16x32_bf16 v[32:35], v[160:163], a[184:187], v[52:55]
    v_exp_f32 v29, v29
    v_mfma_f32_16x16x32_bf16 v[32:35], v[164:167], a[188:191], v[32:35]
    ds_read_b64_tr_b16 v[208:209], v15 offset:0
    v_cvt_pk_bf16_f32 v42, v28, v29
    v_mfma_f32_16x16x32_bf16 v[32:35], v[168:171], a[192:195], v[32:35]
    v_exp_f32 v30, v30
    v_mfma_f32_16x16x32_bf16 v[32:35], v[172:175], a[196:199], v[32:35]
    ds_read_b64_tr_b16 v[210:211], v15 offset:4096
    ds_read_b64_tr_b16 v[212:213], v15 offset:8
    v_mfma_f32_16x16x32_bf16 v[36:39], v[176:179], a[184:187], v[52:55]
    v_exp_f32 v31, v31
    v_mfma_f32_16x16x32_bf16 v[36:39], v[180:183], a[188:191], v[36:39]
    ds_read_b64_tr_b16 v[214:215], v15 offset:4104
    v_cvt_pk_bf16_f32 v43, v30, v31
    v_mfma_f32_16x16x32_bf16 v[36:39], v[184:187], a[192:195], v[36:39]
    s_waitcnt lgkmcnt(6)
    v_mfma_f32_16x16x32_bf16 v[36:39], v[188:191], a[196:199], v[36:39]
    v_exp_f32 v32, v32
    v_mfma_f32_16x16x32_bf16 v[104:107], v[192:195], v[40:43], v[104:107]
    buffer_load_dwordx4 v7, s[16:19], s61 offen offset:1024 lds
    v_mfma_f32_16x16x32_bf16 v[108:111], v[196:199], v[40:43], v[108:111]
    v_exp_f32 v33, v33
    v_mfma_f32_16x16x32_bf16 a[0:3], v[200:203], v[40:43], a[0:3]
    s_waitcnt lgkmcnt(0)
    v_cvt_pk_bf16_f32 v44, v32, v33
    v_mfma_f32_16x16x32_bf16 a[4:7], v[204:207], v[40:43], a[4:7]
    v_exp_f32 v34, v34
    v_mfma_f32_16x16x32_bf16 a[8:11], v[208:211], v[40:43], a[8:11]
    v_mfma_f32_16x16x32_bf16 a[12:15], v[212:215], v[40:43], a[12:15]
    v_exp_f32 v35, v35
    v_mfma_f32_16x16x32_bf16 a[16:19], v[248:251], v[40:43], a[16:19]
    s_add_u32 m0, s34, 12288
    v_cvt_pk_bf16_f32 v45, v34, v35
    v_mfma_f32_16x16x32_bf16 a[20:23], v[252:255], v[40:43], a[20:23]
    v_exp_f32 v36, v36
    v_mfma_f32_16x16x32_bf16 v[76:79], v[20:23], v[40:43], v[76:79]
    buffer_load_dwordx4 v4, s[16:19], s62 offen lds
    v_mfma_f32_16x16x32_bf16 v[24:27], v[160:163], a[200:203], v[56:59]
    v_exp_f32 v37, v37
    v_mfma_f32_16x16x32_bf16 v[24:27], v[164:167], a[204:207], v[24:27]
    v_cvt_pk_bf16_f32 v46, v36, v37
    v_mfma_f32_16x16x32_bf16 v[24:27], v[168:171], a[208:211], v[24:27]
    v_exp_f32 v38, v38
    v_mfma_f32_16x16x32_bf16 v[24:27], v[172:175], a[212:215], v[24:27]
    buffer_load_dwordx4 v5, s[16:19], s62 offen offset:1024 lds
    v_mfma_f32_16x16x32_bf16 v[28:31], v[176:179], a[200:203], v[56:59]
    v_exp_f32 v39, v39
    v_mfma_f32_16x16x32_bf16 v[28:31], v[180:183], a[204:207], v[28:31]
    v_cvt_pk_bf16_f32 v47, v38, v39
    v_mfma_f32_16x16x32_bf16 v[28:31], v[184:187], a[208:211], v[28:31]
    buffer_load_dwordx4 v6, s[16:19], s62 offen offset:2048 lds
    v_mfma_f32_16x16x32_bf16 v[28:31], v[188:191], a[212:215], v[28:31]
    v_exp_f32 v24, v24
    v_mfma_f32_16x16x32_bf16 v[112:115], v[192:195], v[44:47], v[112:115]
    buffer_load_dwordx4 v7, s[16:19], s62 offen offset:3072 lds
    v_mfma_f32_16x16x32_bf16 v[116:119], v[196:199], v[44:47], v[116:119]
    v_exp_f32 v25, v25
    v_mfma_f32_16x16x32_bf16 a[24:27], v[200:203], v[44:47], a[24:27]
    s_add_u32 m0, s34, 26624
    v_cvt_pk_bf16_f32 v40, v24, v25
    v_mfma_f32_16x16x32_bf16 a[28:31], v[204:207], v[44:47], a[28:31]
    v_exp_f32 v26, v26
    v_mfma_f32_16x16x32_bf16 a[32:35], v[208:211], v[44:47], a[32:35]
    buffer_load_dwordx4 v8, s[20:23], s61 offen lds
    v_mfma_f32_16x16x32_bf16 a[36:39], v[212:215], v[44:47], a[36:39]
    v_exp_f32 v27, v27
    v_mfma_f32_16x16x32_bf16 a[40:43], v[248:251], v[44:47], a[40:43]
    v_cvt_pk_bf16_f32 v41, v26, v27
    v_mfma_f32_16x16x32_bf16 a[44:47], v[252:255], v[44:47], a[44:47]
    v_exp_f32 v28, v28
    v_mfma_f32_16x16x32_bf16 v[80:83], v[20:23], v[44:47], v[80:83]
    buffer_load_dwordx4 v8, s[20:23], s61 offen offset:1024 lds
    v_mfma_f32_16x16x32_bf16 v[32:35], v[160:163], a[216:219], v[60:63]
    v_exp_f32 v29, v29
    v_mfma_f32_16x16x32_bf16 v[32:35], v[164:167], a[220:223], v[32:35]
    s_add_u32 m0, s34, 28672
    v_cvt_pk_bf16_f32 v42, v28, v29
    v_mfma_f32_16x16x32_bf16 v[32:35], v[168:171], a[224:227], v[32:35]
    v_exp_f32 v30, v30
    v_mfma_f32_16x16x32_bf16 v[32:35], v[172:175], a[228:231], v[32:35]
    buffer_load_dwordx4 v8, s[20:23], s62 offen lds
    v_mfma_f32_16x16x32_bf16 v[36:39], v[176:179], a[216:219], v[60:63]
    v_exp_f32 v31, v31
    v_mfma_f32_16x16x32_bf16 v[36:39], v[180:183], a[220:223], v[36:39]
    v_cvt_pk_bf16_f32 v43, v30, v31
    v_mfma_f32_16x16x32_bf16 v[36:39], v[184:187], a[224:227], v[36:39]
    buffer_load_dwordx4 v8, s[20:23], s62 offen offset:1024 lds
    v_mfma_f32_16x16x32_bf16 v[36:39], v[188:191], a[228:231], v[36:39]
    v_exp_f32 v32, v32
    v_mfma_f32_16x16x32_bf16 v[120:123], v[192:195], v[40:43], v[120:123]
    v_mfma_f32_16x16x32_bf16 v[124:127], v[196:199], v[40:43], v[124:127]
    v_exp_f32 v33, v33
    v_mfma_f32_16x16x32_bf16 a[48:51], v[200:203], v[40:43], a[48:51]
    v_cvt_pk_bf16_f32 v44, v32, v33
    v_mfma_f32_16x16x32_bf16 a[52:55], v[204:207], v[40:43], a[52:55]
    v_exp_f32 v34, v34
    v_mfma_f32_16x16x32_bf16 a[56:59], v[208:211], v[40:43], a[56:59]
    v_mfma_f32_16x16x32_bf16 a[60:63], v[212:215], v[40:43], a[60:63]
    v_exp_f32 v35, v35
    v_mfma_f32_16x16x32_bf16 a[64:67], v[248:251], v[40:43], a[64:67]
    v_cvt_pk_bf16_f32 v45, v34, v35
    v_mfma_f32_16x16x32_bf16 a[68:71], v[252:255], v[40:43], a[68:71]
    v_exp_f32 v36, v36
    v_mfma_f32_16x16x32_bf16 v[84:87], v[20:23], v[40:43], v[84:87]
    buffer_load_dwordx4 v8, s[20:23], s62 offen offset:2048 lds
    v_mfma_f32_16x16x32_bf16 v[24:27], v[160:163], a[232:235], v[64:67]
    v_exp_f32 v37, v37
    v_mfma_f32_16x16x32_bf16 v[24:27], v[164:167], a[236:239], v[24:27]
    v_cvt_pk_bf16_f32 v46, v36, v37
    v_mfma_f32_16x16x32_bf16 v[24:27], v[168:171], a[240:243], v[24:27]
    v_exp_f32 v38, v38
    v_mfma_f32_16x16x32_bf16 v[24:27], v[172:175], a[244:247], v[24:27]
    buffer_load_dwordx4 v8, s[20:23], s62 offen offset:3072 lds
    v_mfma_f32_16x16x32_bf16 v[28:31], v[176:179], a[232:235], v[64:67]
    v_exp_f32 v39, v39
    v_mfma_f32_16x16x32_bf16 v[28:31], v[180:183], a[236:239], v[28:31]
    s_nop 0
    v_cvt_pk_bf16_f32 v47, v38, v39
    v_mfma_f32_16x16x32_bf16 v[28:31], v[184:187], a[240:243], v[28:31]
    v_mfma_f32_16x16x32_bf16 v[28:31], v[188:191], a[244:247], v[28:31]
    v_exp_f32 v24, v24
    v_mfma_f32_16x16x32_bf16 v[128:131], v[192:195], v[44:47], v[128:131]
    v_mfma_f32_16x16x32_bf16 v[132:135], v[196:199], v[44:47], v[132:135]
    v_exp_f32 v25, v25
    v_mfma_f32_16x16x32_bf16 a[72:75], v[200:203], v[44:47], a[72:75]
    s_add_u32 m0, s34, 0
    v_cvt_pk_bf16_f32 v40, v24, v25
    v_mfma_f32_16x16x32_bf16 a[76:79], v[204:207], v[44:47], a[76:79]
    v_exp_f32 v26, v26
    v_mfma_f32_16x16x32_bf16 a[80:83], v[208:211], v[44:47], a[80:83]
    v_mfma_f32_16x16x32_bf16 a[84:87], v[212:215], v[44:47], a[84:87]
    v_exp_f32 v27, v27
    v_mfma_f32_16x16x32_bf16 a[88:91], v[248:251], v[44:47], a[88:91]
    v_cvt_pk_bf16_f32 v41, v26, v27
    v_mfma_f32_16x16x32_bf16 a[92:95], v[252:255], v[44:47], a[92:95]
    v_exp_f32 v28, v28
    v_mfma_f32_16x16x32_bf16 v[88:91], v[20:23], v[44:47], v[88:91]
    buffer_load_dwordx4 v4, s[16:19], s64 offen lds
    v_mfma_f32_16x16x32_bf16 v[32:35], v[160:163], a[248:251], v[68:71]
    v_exp_f32 v29, v29
    v_mfma_f32_16x16x32_bf16 v[32:35], v[164:167], a[252:255], v[32:35]
    v_cvt_pk_bf16_f32 v42, v28, v29
    v_mfma_f32_16x16x32_bf16 v[32:35], v[168:171], v[224:227], v[32:35]
    v_exp_f32 v30, v30
    v_mfma_f32_16x16x32_bf16 v[32:35], v[172:175], v[228:231], v[32:35]
    buffer_load_dwordx4 v5, s[16:19], s64 offen offset:1024 lds
    v_mfma_f32_16x16x32_bf16 v[36:39], v[176:179], a[248:251], v[68:71]
    v_exp_f32 v31, v31
    v_mfma_f32_16x16x32_bf16 v[36:39], v[180:183], a[252:255], v[36:39]
    s_add_u32 m0, s34, 16384
    v_cvt_pk_bf16_f32 v43, v30, v31
    v_mfma_f32_16x16x32_bf16 v[36:39], v[184:187], v[224:227], v[36:39]
    buffer_load_dwordx4 v8, s[20:23], s64 offen lds
    v_mfma_f32_16x16x32_bf16 v[36:39], v[188:191], v[228:231], v[36:39]
    v_exp_f32 v32, v32
    v_mfma_f32_16x16x32_bf16 v[136:139], v[192:195], v[40:43], v[136:139]
    v_mfma_f32_16x16x32_bf16 v[140:143], v[196:199], v[40:43], v[140:143]
    v_exp_f32 v33, v33
    v_mfma_f32_16x16x32_bf16 a[96:99], v[200:203], v[40:43], a[96:99]
    v_cvt_pk_bf16_f32 v44, v32, v33
    v_mfma_f32_16x16x32_bf16 a[100:103], v[204:207], v[40:43], a[100:103]
    v_exp_f32 v34, v34
    v_mfma_f32_16x16x32_bf16 a[104:107], v[208:211], v[40:43], a[104:107]
    buffer_load_dwordx4 v8, s[20:23], s64 offen offset:1024 lds
    v_mfma_f32_16x16x32_bf16 a[108:111], v[212:215], v[40:43], a[108:111]
    v_exp_f32 v35, v35
    v_mfma_f32_16x16x32_bf16 a[112:115], v[248:251], v[40:43], a[112:115]
    v_cvt_pk_bf16_f32 v45, v34, v35
    v_mfma_f32_16x16x32_bf16 a[116:119], v[252:255], v[40:43], a[116:119]
    v_exp_f32 v36, v36
    v_mfma_f32_16x16x32_bf16 v[92:95], v[20:23], v[40:43], v[92:95]
    s_waitcnt vmcnt(10)
    v_mfma_f32_16x16x32_bf16 v[24:27], v[160:163], v[232:235], v[72:75]
    v_exp_f32 v37, v37
    v_mfma_f32_16x16x32_bf16 v[24:27], v[164:167], v[236:239], v[24:27]
    ds_read_b128 v[160:163], v9 offset:8192
    v_cvt_pk_bf16_f32 v46, v36, v37
    v_mfma_f32_16x16x32_bf16 v[24:27], v[168:171], v[240:243], v[24:27]
    v_exp_f32 v38, v38
    v_mfma_f32_16x16x32_bf16 v[24:27], v[172:175], v[244:247], v[24:27]
    ds_read_b128 v[164:167], v10 offset:8192
    ds_read_b128 v[168:171], v11 offset:8192
    v_mfma_f32_16x16x32_bf16 v[28:31], v[176:179], v[232:235], v[72:75]
    v_exp_f32 v39, v39
    v_mfma_f32_16x16x32_bf16 v[28:31], v[180:183], v[236:239], v[28:31]
    ds_read_b128 v[172:175], v12 offset:8192
    v_cvt_pk_bf16_f32 v47, v38, v39
    v_mfma_f32_16x16x32_bf16 v[28:31], v[184:187], v[240:243], v[28:31]
    ds_read_b128 v[176:179], v9 offset:12288
    ds_read_b128 v[180:183], v10 offset:12288
    v_mfma_f32_16x16x32_bf16 v[28:31], v[188:191], v[244:247], v[28:31]
    v_exp_f32 v24, v24
    v_mfma_f32_16x16x32_bf16 v[144:147], v[192:195], v[44:47], v[144:147]
    ds_read_b128 v[184:187], v11 offset:12288
    ds_read_b128 v[188:191], v12 offset:12288
    v_mfma_f32_16x16x32_bf16 v[148:151], v[196:199], v[44:47], v[148:151]
    v_exp_f32 v25, v25
    v_mfma_f32_16x16x32_bf16 a[120:123], v[200:203], v[44:47], a[120:123]
    s_add_u32 m0, s34, 2048
    v_cvt_pk_bf16_f32 v40, v24, v25
    v_mfma_f32_16x16x32_bf16 a[124:127], v[204:207], v[44:47], a[124:127]
    v_exp_f32 v26, v26
    v_mfma_f32_16x16x32_bf16 a[128:131], v[208:211], v[44:47], a[128:131]
    s_waitcnt vmcnt(4)
    v_mfma_f32_16x16x32_bf16 a[132:135], v[212:215], v[44:47], a[132:135]
    v_exp_f32 v27, v27
    v_mfma_f32_16x16x32_bf16 a[136:139], v[248:251], v[44:47], a[136:139]
    ds_read_b64_tr_b16 v[216:217], v16 offset:8192
    v_cvt_pk_bf16_f32 v41, v26, v27
    v_mfma_f32_16x16x32_bf16 a[140:143], v[252:255], v[44:47], a[140:143]
    v_exp_f32 v28, v28
    v_mfma_f32_16x16x32_bf16 v[96:99], v[20:23], v[44:47], v[96:99]
    s_waitcnt lgkmcnt(1)
    ds_read_b64_tr_b16 v[218:219], v16 offset:12288
    v_mfma_f32_16x16x32_bf16 v[32:35], v[160:163], a[168:171], v[48:51]
    v_exp_f32 v29, v29
    v_mfma_f32_16x16x32_bf16 v[32:35], v[164:167], a[172:175], v[32:35]
    ds_read_b64_tr_b16 v[220:221], v16 offset:8200
    v_cvt_pk_bf16_f32 v42, v28, v29
    v_mfma_f32_16x16x32_bf16 v[32:35], v[168:171], a[176:179], v[32:35]
    v_exp_f32 v30, v30
    v_mfma_f32_16x16x32_bf16 v[32:35], v[172:175], a[180:183], v[32:35]
    ds_read_b64_tr_b16 v[222:223], v16 offset:12296
    v_mfma_f32_16x16x32_bf16 v[36:39], v[176:179], a[168:171], v[48:51]
    v_exp_f32 v31, v31
    v_mfma_f32_16x16x32_bf16 v[36:39], v[180:183], a[172:175], v[36:39]
    v_cvt_pk_bf16_f32 v43, v30, v31
    v_mfma_f32_16x16x32_bf16 v[36:39], v[184:187], a[176:179], v[36:39]
    buffer_load_dwordx4 v6, s[16:19], s65 offen lds
    v_mfma_f32_16x16x32_bf16 v[36:39], v[188:191], a[180:183], v[36:39]
    v_exp_f32 v32, v32
    v_mfma_f32_16x16x32_bf16 v[152:155], v[192:195], v[40:43], v[152:155]
    ds_read_b64_tr_b16 v[192:193], v13 offset:8192
    ds_read_b64_tr_b16 v[194:195], v13 offset:12288
    v_mfma_f32_16x16x32_bf16 v[156:159], v[196:199], v[40:43], v[156:159]
    v_exp_f32 v33, v33
    v_mfma_f32_16x16x32_bf16 a[144:147], v[200:203], v[40:43], a[144:147]
    ds_read_b64_tr_b16 v[196:197], v13 offset:8200
    v_cvt_pk_bf16_f32 v44, v32, v33
    v_mfma_f32_16x16x32_bf16 a[148:151], v[204:207], v[40:43], a[148:151]
    v_exp_f32 v34, v34
    v_mfma_f32_16x16x32_bf16 a[152:155], v[208:211], v[40:43], a[152:155]
    ds_read_b64_tr_b16 v[198:199], v13 offset:12296
    ds_read_b64_tr_b16 v[200:201], v14 offset:8192
    v_mfma_f32_16x16x32_bf16 a[156:159], v[212:215], v[40:43], a[156:159]
    v_exp_f32 v35, v35
    v_mfma_f32_16x16x32_bf16 a[160:163], v[248:251], v[40:43], a[160:163]
    ds_read_b64_tr_b16 v[202:203], v14 offset:12288
    v_cvt_pk_bf16_f32 v45, v34, v35
    v_mfma_f32_16x16x32_bf16 a[164:167], v[252:255], v[40:43], a[164:167]
    v_exp_f32 v36, v36
    v_mfma_f32_16x16x32_bf16 v[100:103], v[20:23], v[40:43], v[100:103]
    ds_read_b64_tr_b16 v[204:205], v14 offset:8200
    ds_read_b64_tr_b16 v[206:207], v14 offset:12296
    v_mfma_f32_16x16x32_bf16 v[24:27], v[160:163], a[184:187], v[52:55]
    v_exp_f32 v37, v37
    v_mfma_f32_16x16x32_bf16 v[24:27], v[164:167], a[188:191], v[24:27]
    ds_read_b64_tr_b16 v[208:209], v15 offset:8192
    v_cvt_pk_bf16_f32 v46, v36, v37
    v_mfma_f32_16x16x32_bf16 v[24:27], v[168:171], a[192:195], v[24:27]
    v_exp_f32 v38, v38
    v_mfma_f32_16x16x32_bf16 v[24:27], v[172:175], a[196:199], v[24:27]
    ds_read_b64_tr_b16 v[210:211], v15 offset:12288
    ds_read_b64_tr_b16 v[212:213], v15 offset:8200
    v_mfma_f32_16x16x32_bf16 v[28:31], v[176:179], a[184:187], v[52:55]
    v_exp_f32 v39, v39
    v_mfma_f32_16x16x32_bf16 v[28:31], v[180:183], a[188:191], v[28:31]
    ds_read_b64_tr_b16 v[214:215], v15 offset:12296
    v_cvt_pk_bf16_f32 v47, v38, v39
    v_mfma_f32_16x16x32_bf16 v[28:31], v[184:187], a[192:195], v[28:31]
    s_waitcnt lgkmcnt(6)
    v_mfma_f32_16x16x32_bf16 v[28:31], v[188:191], a[196:199], v[28:31]
    v_exp_f32 v24, v24
    v_mfma_f32_16x16x32_bf16 v[104:107], v[192:195], v[44:47], v[104:107]
    buffer_load_dwordx4 v7, s[16:19], s65 offen offset:1024 lds
    v_mfma_f32_16x16x32_bf16 v[108:111], v[196:199], v[44:47], v[108:111]
    v_exp_f32 v25, v25
    v_mfma_f32_16x16x32_bf16 a[0:3], v[200:203], v[44:47], a[0:3]
    s_waitcnt lgkmcnt(0)
    v_cvt_pk_bf16_f32 v40, v24, v25
    v_mfma_f32_16x16x32_bf16 a[4:7], v[204:207], v[44:47], a[4:7]
    v_exp_f32 v26, v26
    v_mfma_f32_16x16x32_bf16 a[8:11], v[208:211], v[44:47], a[8:11]
    v_mfma_f32_16x16x32_bf16 a[12:15], v[212:215], v[44:47], a[12:15]
    v_exp_f32 v27, v27
    v_mfma_f32_16x16x32_bf16 a[16:19], v[216:219], v[44:47], a[16:19]
    s_add_u32 m0, s34, 4096
    v_cvt_pk_bf16_f32 v41, v26, v27
    v_mfma_f32_16x16x32_bf16 a[20:23], v[220:223], v[44:47], a[20:23]
    v_exp_f32 v28, v28
    v_mfma_f32_16x16x32_bf16 v[76:79], v[20:23], v[44:47], v[76:79]
    buffer_load_dwordx4 v4, s[16:19], s66 offen lds
    v_mfma_f32_16x16x32_bf16 v[32:35], v[160:163], a[200:203], v[56:59]
    v_exp_f32 v29, v29
    v_mfma_f32_16x16x32_bf16 v[32:35], v[164:167], a[204:207], v[32:35]
    v_cvt_pk_bf16_f32 v42, v28, v29
    v_mfma_f32_16x16x32_bf16 v[32:35], v[168:171], a[208:211], v[32:35]
    v_exp_f32 v30, v30
    v_mfma_f32_16x16x32_bf16 v[32:35], v[172:175], a[212:215], v[32:35]
    buffer_load_dwordx4 v5, s[16:19], s66 offen offset:1024 lds
    v_mfma_f32_16x16x32_bf16 v[36:39], v[176:179], a[200:203], v[56:59]
    v_exp_f32 v31, v31
    v_mfma_f32_16x16x32_bf16 v[36:39], v[180:183], a[204:207], v[36:39]
    v_cvt_pk_bf16_f32 v43, v30, v31
    v_mfma_f32_16x16x32_bf16 v[36:39], v[184:187], a[208:211], v[36:39]
    buffer_load_dwordx4 v6, s[16:19], s66 offen offset:2048 lds
    v_mfma_f32_16x16x32_bf16 v[36:39], v[188:191], a[212:215], v[36:39]
    v_exp_f32 v32, v32
    v_mfma_f32_16x16x32_bf16 v[112:115], v[192:195], v[40:43], v[112:115]
    buffer_load_dwordx4 v7, s[16:19], s66 offen offset:3072 lds
    v_mfma_f32_16x16x32_bf16 v[116:119], v[196:199], v[40:43], v[116:119]
    v_exp_f32 v33, v33
    v_mfma_f32_16x16x32_bf16 a[24:27], v[200:203], v[40:43], a[24:27]
    s_add_u32 m0, s34, 18432
    v_cvt_pk_bf16_f32 v44, v32, v33
    v_mfma_f32_16x16x32_bf16 a[28:31], v[204:207], v[40:43], a[28:31]
    v_exp_f32 v34, v34
    v_mfma_f32_16x16x32_bf16 a[32:35], v[208:211], v[40:43], a[32:35]
    buffer_load_dwordx4 v8, s[20:23], s65 offen lds
    v_mfma_f32_16x16x32_bf16 a[36:39], v[212:215], v[40:43], a[36:39]
    v_exp_f32 v35, v35
    v_mfma_f32_16x16x32_bf16 a[40:43], v[216:219], v[40:43], a[40:43]
    v_cvt_pk_bf16_f32 v45, v34, v35
    v_mfma_f32_16x16x32_bf16 a[44:47], v[220:223], v[40:43], a[44:47]
    v_exp_f32 v36, v36
    v_mfma_f32_16x16x32_bf16 v[80:83], v[20:23], v[40:43], v[80:83]
    buffer_load_dwordx4 v8, s[20:23], s65 offen offset:1024 lds
    v_mfma_f32_16x16x32_bf16 v[24:27], v[160:163], a[216:219], v[60:63]
    v_exp_f32 v37, v37
    v_mfma_f32_16x16x32_bf16 v[24:27], v[164:167], a[220:223], v[24:27]
    s_add_u32 m0, s34, 20480
    v_cvt_pk_bf16_f32 v46, v36, v37
    v_mfma_f32_16x16x32_bf16 v[24:27], v[168:171], a[224:227], v[24:27]
    v_exp_f32 v38, v38
    v_mfma_f32_16x16x32_bf16 v[24:27], v[172:175], a[228:231], v[24:27]
    buffer_load_dwordx4 v8, s[20:23], s66 offen lds
    v_mfma_f32_16x16x32_bf16 v[28:31], v[176:179], a[216:219], v[60:63]
    v_exp_f32 v39, v39
    v_mfma_f32_16x16x32_bf16 v[28:31], v[180:183], a[220:223], v[28:31]
    v_cvt_pk_bf16_f32 v47, v38, v39
    v_mfma_f32_16x16x32_bf16 v[28:31], v[184:187], a[224:227], v[28:31]
    buffer_load_dwordx4 v8, s[20:23], s66 offen offset:1024 lds
    v_mfma_f32_16x16x32_bf16 v[28:31], v[188:191], a[228:231], v[28:31]
    v_exp_f32 v24, v24
    v_mfma_f32_16x16x32_bf16 v[120:123], v[192:195], v[44:47], v[120:123]
    v_mfma_f32_16x16x32_bf16 v[124:127], v[196:199], v[44:47], v[124:127]
    v_exp_f32 v25, v25
    v_mfma_f32_16x16x32_bf16 a[48:51], v[200:203], v[44:47], a[48:51]
    v_cvt_pk_bf16_f32 v40, v24, v25
    v_mfma_f32_16x16x32_bf16 a[52:55], v[204:207], v[44:47], a[52:55]
    v_exp_f32 v26, v26
    v_mfma_f32_16x16x32_bf16 a[56:59], v[208:211], v[44:47], a[56:59]
    v_mfma_f32_16x16x32_bf16 a[60:63], v[212:215], v[44:47], a[60:63]
    v_exp_f32 v27, v27
    v_mfma_f32_16x16x32_bf16 a[64:67], v[216:219], v[44:47], a[64:67]
    v_cvt_pk_bf16_f32 v41, v26, v27
    v_mfma_f32_16x16x32_bf16 a[68:71], v[220:223], v[44:47], a[68:71]
    v_exp_f32 v28, v28
    v_mfma_f32_16x16x32_bf16 v[84:87], v[20:23], v[44:47], v[84:87]
    buffer_load_dwordx4 v8, s[20:23], s66 offen offset:2048 lds
    v_mfma_f32_16x16x32_bf16 v[32:35], v[160:163], a[232:235], v[64:67]
    v_exp_f32 v29, v29
    v_mfma_f32_16x16x32_bf16 v[32:35], v[164:167], a[236:239], v[32:35]
    v_cvt_pk_bf16_f32 v42, v28, v29
    v_mfma_f32_16x16x32_bf16 v[32:35], v[168:171], a[240:243], v[32:35]
    v_exp_f32 v30, v30
    v_mfma_f32_16x16x32_bf16 v[32:35], v[172:175], a[244:247], v[32:35]
    buffer_load_dwordx4 v8, s[20:23], s66 offen offset:3072 lds
    v_mfma_f32_16x16x32_bf16 v[36:39], v[176:179], a[232:235], v[64:67]
    v_exp_f32 v31, v31
    v_mfma_f32_16x16x32_bf16 v[36:39], v[180:183], a[236:239], v[36:39]
    s_nop 0
    v_cvt_pk_bf16_f32 v43, v30, v31
    v_mfma_f32_16x16x32_bf16 v[36:39], v[184:187], a[240:243], v[36:39]
    v_mfma_f32_16x16x32_bf16 v[36:39], v[188:191], a[244:247], v[36:39]
    v_exp_f32 v32, v32
    v_mfma_f32_16x16x32_bf16 v[128:131], v[192:195], v[40:43], v[128:131]
    v_mfma_f32_16x16x32_bf16 v[132:135], v[196:199], v[40:43], v[132:135]
    v_exp_f32 v33, v33
    v_mfma_f32_16x16x32_bf16 a[72:75], v[200:203], v[40:43], a[72:75]
    s_add_u32 m0, s34, 8192
    v_cvt_pk_bf16_f32 v44, v32, v33
    v_mfma_f32_16x16x32_bf16 a[76:79], v[204:207], v[40:43], a[76:79]
    v_exp_f32 v34, v34
    v_mfma_f32_16x16x32_bf16 a[80:83], v[208:211], v[40:43], a[80:83]
    v_mfma_f32_16x16x32_bf16 a[84:87], v[212:215], v[40:43], a[84:87]
    v_exp_f32 v35, v35
    v_mfma_f32_16x16x32_bf16 a[88:91], v[216:219], v[40:43], a[88:91]
    v_cvt_pk_bf16_f32 v45, v34, v35
    v_mfma_f32_16x16x32_bf16 a[92:95], v[220:223], v[40:43], a[92:95]
    v_exp_f32 v36, v36
    v_mfma_f32_16x16x32_bf16 v[88:91], v[20:23], v[40:43], v[88:91]
    buffer_load_dwordx4 v4, s[16:19], s68 offen lds
    v_mfma_f32_16x16x32_bf16 v[24:27], v[160:163], a[248:251], v[68:71]
    v_exp_f32 v37, v37
    v_mfma_f32_16x16x32_bf16 v[24:27], v[164:167], a[252:255], v[24:27]
    v_cvt_pk_bf16_f32 v46, v36, v37
    v_mfma_f32_16x16x32_bf16 v[24:27], v[168:171], v[224:227], v[24:27]
    v_exp_f32 v38, v38
    v_mfma_f32_16x16x32_bf16 v[24:27], v[172:175], v[228:231], v[24:27]
    buffer_load_dwordx4 v5, s[16:19], s68 offen offset:1024 lds
    v_mfma_f32_16x16x32_bf16 v[28:31], v[176:179], a[248:251], v[68:71]
    v_exp_f32 v39, v39
    v_mfma_f32_16x16x32_bf16 v[28:31], v[180:183], a[252:255], v[28:31]
    s_add_u32 m0, s34, 24576
    v_cvt_pk_bf16_f32 v47, v38, v39
    v_mfma_f32_16x16x32_bf16 v[28:31], v[184:187], v[224:227], v[28:31]
    buffer_load_dwordx4 v8, s[20:23], s68 offen lds
    v_mfma_f32_16x16x32_bf16 v[28:31], v[188:191], v[228:231], v[28:31]
    v_exp_f32 v24, v24
    v_mfma_f32_16x16x32_bf16 v[136:139], v[192:195], v[44:47], v[136:139]
    v_mfma_f32_16x16x32_bf16 v[140:143], v[196:199], v[44:47], v[140:143]
    v_exp_f32 v25, v25
    v_mfma_f32_16x16x32_bf16 a[96:99], v[200:203], v[44:47], a[96:99]
    v_cvt_pk_bf16_f32 v40, v24, v25
    v_mfma_f32_16x16x32_bf16 a[100:103], v[204:207], v[44:47], a[100:103]
    v_exp_f32 v26, v26
    v_mfma_f32_16x16x32_bf16 a[104:107], v[208:211], v[44:47], a[104:107]
    buffer_load_dwordx4 v8, s[20:23], s68 offen offset:1024 lds
    v_mfma_f32_16x16x32_bf16 a[108:111], v[212:215], v[44:47], a[108:111]
    v_exp_f32 v27, v27
    v_mfma_f32_16x16x32_bf16 a[112:115], v[216:219], v[44:47], a[112:115]
    v_cvt_pk_bf16_f32 v41, v26, v27
    v_mfma_f32_16x16x32_bf16 a[116:119], v[220:223], v[44:47], a[116:119]
    v_exp_f32 v28, v28
    v_mfma_f32_16x16x32_bf16 v[92:95], v[20:23], v[44:47], v[92:95]
    s_waitcnt vmcnt(10)
    v_mfma_f32_16x16x32_bf16 v[32:35], v[160:163], v[232:235], v[72:75]
    v_exp_f32 v29, v29
    v_mfma_f32_16x16x32_bf16 v[32:35], v[164:167], v[236:239], v[32:35]
    ds_read_b128 v[160:163], v9 offset:0
    v_cvt_pk_bf16_f32 v42, v28, v29
    v_mfma_f32_16x16x32_bf16 v[32:35], v[168:171], v[240:243], v[32:35]
    v_exp_f32 v30, v30
    v_mfma_f32_16x16x32_bf16 v[32:35], v[172:175], v[244:247], v[32:35]
    ds_read_b128 v[164:167], v10 offset:0
    ds_read_b128 v[168:171], v11 offset:0
    v_mfma_f32_16x16x32_bf16 v[36:39], v[176:179], v[232:235], v[72:75]
    v_exp_f32 v31, v31
    v_mfma_f32_16x16x32_bf16 v[36:39], v[180:183], v[236:239], v[36:39]
    ds_read_b128 v[172:175], v12 offset:0
    v_cvt_pk_bf16_f32 v43, v30, v31
    v_mfma_f32_16x16x32_bf16 v[36:39], v[184:187], v[240:243], v[36:39]
    ds_read_b128 v[176:179], v9 offset:4096
    ds_read_b128 v[180:183], v10 offset:4096
    v_mfma_f32_16x16x32_bf16 v[36:39], v[188:191], v[244:247], v[36:39]
    v_exp_f32 v32, v32
    v_mfma_f32_16x16x32_bf16 v[144:147], v[192:195], v[40:43], v[144:147]
    ds_read_b128 v[184:187], v11 offset:4096
    ds_read_b128 v[188:191], v12 offset:4096
    v_mfma_f32_16x16x32_bf16 v[148:151], v[196:199], v[40:43], v[148:151]
    v_exp_f32 v33, v33
    v_mfma_f32_16x16x32_bf16 a[120:123], v[200:203], v[40:43], a[120:123]
    s_add_u32 m0, s34, 10240
    v_cvt_pk_bf16_f32 v44, v32, v33
    v_mfma_f32_16x16x32_bf16 a[124:127], v[204:207], v[40:43], a[124:127]
    v_exp_f32 v34, v34
    v_mfma_f32_16x16x32_bf16 a[128:131], v[208:211], v[40:43], a[128:131]
    s_waitcnt vmcnt(4)
    v_mfma_f32_16x16x32_bf16 a[132:135], v[212:215], v[40:43], a[132:135]
    v_exp_f32 v35, v35
    v_mfma_f32_16x16x32_bf16 a[136:139], v[216:219], v[40:43], a[136:139]
    ds_read_b64_tr_b16 v[248:249], v16 offset:0
    v_cvt_pk_bf16_f32 v45, v34, v35
    v_mfma_f32_16x16x32_bf16 a[140:143], v[220:223], v[40:43], a[140:143]
    v_exp_f32 v36, v36
    v_mfma_f32_16x16x32_bf16 v[96:99], v[20:23], v[40:43], v[96:99]
    s_waitcnt lgkmcnt(1)
    ds_read_b64_tr_b16 v[250:251], v16 offset:4096
    v_mfma_f32_16x16x32_bf16 v[24:27], v[160:163], a[168:171], v[48:51]
    v_exp_f32 v37, v37
    v_mfma_f32_16x16x32_bf16 v[24:27], v[164:167], a[172:175], v[24:27]
    ds_read_b64_tr_b16 v[252:253], v16 offset:8
    v_cvt_pk_bf16_f32 v46, v36, v37
    v_mfma_f32_16x16x32_bf16 v[24:27], v[168:171], a[176:179], v[24:27]
    v_exp_f32 v38, v38
    v_mfma_f32_16x16x32_bf16 v[24:27], v[172:175], a[180:183], v[24:27]
    ds_read_b64_tr_b16 v[254:255], v16 offset:4104
    v_mfma_f32_16x16x32_bf16 v[28:31], v[176:179], a[168:171], v[48:51]
    v_exp_f32 v39, v39
    v_mfma_f32_16x16x32_bf16 v[28:31], v[180:183], a[172:175], v[28:31]
    v_cvt_pk_bf16_f32 v47, v38, v39
    v_mfma_f32_16x16x32_bf16 v[28:31], v[184:187], a[176:179], v[28:31]
    buffer_load_dwordx4 v6, s[16:19], s69 offen lds
    v_mfma_f32_16x16x32_bf16 v[28:31], v[188:191], a[180:183], v[28:31]
    v_exp_f32 v24, v24
    v_mfma_f32_16x16x32_bf16 v[152:155], v[192:195], v[44:47], v[152:155]
    ds_read_b64_tr_b16 v[192:193], v13 offset:0
    ds_read_b64_tr_b16 v[194:195], v13 offset:4096
    v_mfma_f32_16x16x32_bf16 v[156:159], v[196:199], v[44:47], v[156:159]
    v_exp_f32 v25, v25
    v_mfma_f32_16x16x32_bf16 a[144:147], v[200:203], v[44:47], a[144:147]
    ds_read_b64_tr_b16 v[196:197], v13 offset:8
    v_cvt_pk_bf16_f32 v40, v24, v25
    v_mfma_f32_16x16x32_bf16 a[148:151], v[204:207], v[44:47], a[148:151]
    v_exp_f32 v26, v26
    v_mfma_f32_16x16x32_bf16 a[152:155], v[208:211], v[44:47], a[152:155]
    ds_read_b64_tr_b16 v[198:199], v13 offset:4104
    ds_read_b64_tr_b16 v[200:201], v14 offset:0
    v_mfma_f32_16x16x32_bf16 a[156:159], v[212:215], v[44:47], a[156:159]
    v_exp_f32 v27, v27
    v_mfma_f32_16x16x32_bf16 a[160:163], v[216:219], v[44:47], a[160:163]
    ds_read_b64_tr_b16 v[202:203], v14 offset:4096
    v_cvt_pk_bf16_f32 v41, v26, v27
    v_mfma_f32_16x16x32_bf16 a[164:167], v[220:223], v[44:47], a[164:167]
    v_exp_f32 v28, v28
    v_mfma_f32_16x16x32_bf16 v[100:103], v[20:23], v[44:47], v[100:103]
    ds_read_b64_tr_b16 v[204:205], v14 offset:8
    ds_read_b64_tr_b16 v[206:207], v14 offset:4104
    v_mfma_f32_16x16x32_bf16 v[32:35], v[160:163], a[184:187], v[52:55]
    v_exp_f32 v29, v29
    v_mfma_f32_16x16x32_bf16 v[32:35], v[164:167], a[188:191], v[32:35]
    ds_read_b64_tr_b16 v[208:209], v15 offset:0
    v_cvt_pk_bf16_f32 v42, v28, v29
    v_mfma_f32_16x16x32_bf16 v[32:35], v[168:171], a[192:195], v[32:35]
    v_exp_f32 v30, v30
    v_mfma_f32_16x16x32_bf16 v[32:35], v[172:175], a[196:199], v[32:35]
    ds_read_b64_tr_b16 v[210:211], v15 offset:4096
    ds_read_b64_tr_b16 v[212:213], v15 offset:8
    v_mfma_f32_16x16x32_bf16 v[36:39], v[176:179], a[184:187], v[52:55]
    v_exp_f32 v31, v31
    v_mfma_f32_16x16x32_bf16 v[36:39], v[180:183], a[188:191], v[36:39]
    ds_read_b64_tr_b16 v[214:215], v15 offset:4104
    v_cvt_pk_bf16_f32 v43, v30, v31
    v_mfma_f32_16x16x32_bf16 v[36:39], v[184:187], a[192:195], v[36:39]
    s_waitcnt lgkmcnt(6)
    v_mfma_f32_16x16x32_bf16 v[36:39], v[188:191], a[196:199], v[36:39]
    v_exp_f32 v32, v32
    v_mfma_f32_16x16x32_bf16 v[104:107], v[192:195], v[40:43], v[104:107]
    buffer_load_dwordx4 v7, s[16:19], s69 offen offset:1024 lds
    v_mfma_f32_16x16x32_bf16 v[108:111], v[196:199], v[40:43], v[108:111]
    v_exp_f32 v33, v33
    v_mfma_f32_16x16x32_bf16 a[0:3], v[200:203], v[40:43], a[0:3]
    s_waitcnt lgkmcnt(0)
    v_cvt_pk_bf16_f32 v44, v32, v33
    v_mfma_f32_16x16x32_bf16 a[4:7], v[204:207], v[40:43], a[4:7]
    v_exp_f32 v34, v34
    v_mfma_f32_16x16x32_bf16 a[8:11], v[208:211], v[40:43], a[8:11]
    v_mfma_f32_16x16x32_bf16 a[12:15], v[212:215], v[40:43], a[12:15]
    v_exp_f32 v35, v35
    v_mfma_f32_16x16x32_bf16 a[16:19], v[248:251], v[40:43], a[16:19]
    s_add_u32 m0, s34, 12288
    v_cvt_pk_bf16_f32 v45, v34, v35
    v_mfma_f32_16x16x32_bf16 a[20:23], v[252:255], v[40:43], a[20:23]
    v_exp_f32 v36, v36
    v_mfma_f32_16x16x32_bf16 v[76:79], v[20:23], v[40:43], v[76:79]
    buffer_load_dwordx4 v4, s[16:19], s70 offen lds
    v_mfma_f32_16x16x32_bf16 v[24:27], v[160:163], a[200:203], v[56:59]
    v_exp_f32 v37, v37
    v_mfma_f32_16x16x32_bf16 v[24:27], v[164:167], a[204:207], v[24:27]
    v_cvt_pk_bf16_f32 v46, v36, v37
    v_mfma_f32_16x16x32_bf16 v[24:27], v[168:171], a[208:211], v[24:27]
    v_exp_f32 v38, v38
    v_mfma_f32_16x16x32_bf16 v[24:27], v[172:175], a[212:215], v[24:27]
    buffer_load_dwordx4 v5, s[16:19], s70 offen offset:1024 lds
    v_mfma_f32_16x16x32_bf16 v[28:31], v[176:179], a[200:203], v[56:59]
    v_exp_f32 v39, v39
    v_mfma_f32_16x16x32_bf16 v[28:31], v[180:183], a[204:207], v[28:31]
    v_cvt_pk_bf16_f32 v47, v38, v39
    v_mfma_f32_16x16x32_bf16 v[28:31], v[184:187], a[208:211], v[28:31]
    buffer_load_dwordx4 v6, s[16:19], s70 offen offset:2048 lds
    v_mfma_f32_16x16x32_bf16 v[28:31], v[188:191], a[212:215], v[28:31]
    v_exp_f32 v24, v24
    v_mfma_f32_16x16x32_bf16 v[112:115], v[192:195], v[44:47], v[112:115]
    buffer_load_dwordx4 v7, s[16:19], s70 offen offset:3072 lds
    v_mfma_f32_16x16x32_bf16 v[116:119], v[196:199], v[44:47], v[116:119]
    v_exp_f32 v25, v25
    v_mfma_f32_16x16x32_bf16 a[24:27], v[200:203], v[44:47], a[24:27]
    s_add_u32 m0, s34, 26624
    v_cvt_pk_bf16_f32 v40, v24, v25
    v_mfma_f32_16x16x32_bf16 a[28:31], v[204:207], v[44:47], a[28:31]
    v_exp_f32 v26, v26
    v_mfma_f32_16x16x32_bf16 a[32:35], v[208:211], v[44:47], a[32:35]
    buffer_load_dwordx4 v8, s[20:23], s69 offen lds
    v_mfma_f32_16x16x32_bf16 a[36:39], v[212:215], v[44:47], a[36:39]
    v_exp_f32 v27, v27
    v_mfma_f32_16x16x32_bf16 a[40:43], v[248:251], v[44:47], a[40:43]
    v_cvt_pk_bf16_f32 v41, v26, v27
    v_mfma_f32_16x16x32_bf16 a[44:47], v[252:255], v[44:47], a[44:47]
    v_exp_f32 v28, v28
    v_mfma_f32_16x16x32_bf16 v[80:83], v[20:23], v[44:47], v[80:83]
    buffer_load_dwordx4 v8, s[20:23], s69 offen offset:1024 lds
    v_mfma_f32_16x16x32_bf16 v[32:35], v[160:163], a[216:219], v[60:63]
    v_exp_f32 v29, v29
    v_mfma_f32_16x16x32_bf16 v[32:35], v[164:167], a[220:223], v[32:35]
    s_add_u32 m0, s34, 28672
    v_cvt_pk_bf16_f32 v42, v28, v29
    v_mfma_f32_16x16x32_bf16 v[32:35], v[168:171], a[224:227], v[32:35]
    v_exp_f32 v30, v30
    v_mfma_f32_16x16x32_bf16 v[32:35], v[172:175], a[228:231], v[32:35]
    buffer_load_dwordx4 v8, s[20:23], s70 offen lds
    v_mfma_f32_16x16x32_bf16 v[36:39], v[176:179], a[216:219], v[60:63]
    v_exp_f32 v31, v31
    v_mfma_f32_16x16x32_bf16 v[36:39], v[180:183], a[220:223], v[36:39]
    v_cvt_pk_bf16_f32 v43, v30, v31
    v_mfma_f32_16x16x32_bf16 v[36:39], v[184:187], a[224:227], v[36:39]
    buffer_load_dwordx4 v8, s[20:23], s70 offen offset:1024 lds
    v_mfma_f32_16x16x32_bf16 v[36:39], v[188:191], a[228:231], v[36:39]
    v_exp_f32 v32, v32
    v_mfma_f32_16x16x32_bf16 v[120:123], v[192:195], v[40:43], v[120:123]
    v_mfma_f32_16x16x32_bf16 v[124:127], v[196:199], v[40:43], v[124:127]
    v_exp_f32 v33, v33
    v_mfma_f32_16x16x32_bf16 a[48:51], v[200:203], v[40:43], a[48:51]
    v_cvt_pk_bf16_f32 v44, v32, v33
    v_mfma_f32_16x16x32_bf16 a[52:55], v[204:207], v[40:43], a[52:55]
    v_exp_f32 v34, v34
    v_mfma_f32_16x16x32_bf16 a[56:59], v[208:211], v[40:43], a[56:59]
    v_mfma_f32_16x16x32_bf16 a[60:63], v[212:215], v[40:43], a[60:63]
    v_exp_f32 v35, v35
    v_mfma_f32_16x16x32_bf16 a[64:67], v[248:251], v[40:43], a[64:67]
    v_cvt_pk_bf16_f32 v45, v34, v35
    v_mfma_f32_16x16x32_bf16 a[68:71], v[252:255], v[40:43], a[68:71]
    v_exp_f32 v36, v36
    v_mfma_f32_16x16x32_bf16 v[84:87], v[20:23], v[40:43], v[84:87]
    buffer_load_dwordx4 v8, s[20:23], s70 offen offset:2048 lds
    v_mfma_f32_16x16x32_bf16 v[24:27], v[160:163], a[232:235], v[64:67]
    v_exp_f32 v37, v37
    v_mfma_f32_16x16x32_bf16 v[24:27], v[164:167], a[236:239], v[24:27]
    v_cvt_pk_bf16_f32 v46, v36, v37
    v_mfma_f32_16x16x32_bf16 v[24:27], v[168:171], a[240:243], v[24:27]
    v_exp_f32 v38, v38
    v_mfma_f32_16x16x32_bf16 v[24:27], v[172:175], a[244:247], v[24:27]
    buffer_load_dwordx4 v8, s[20:23], s70 offen offset:3072 lds
    v_mfma_f32_16x16x32_bf16 v[28:31], v[176:179], a[232:235], v[64:67]
    v_exp_f32 v39, v39
    v_mfma_f32_16x16x32_bf16 v[28:31], v[180:183], a[236:239], v[28:31]
    s_nop 0
    v_cvt_pk_bf16_f32 v47, v38, v39
    v_mfma_f32_16x16x32_bf16 v[28:31], v[184:187], a[240:243], v[28:31]
    v_mfma_f32_16x16x32_bf16 v[28:31], v[188:191], a[244:247], v[28:31]
    v_exp_f32 v24, v24
    v_mfma_f32_16x16x32_bf16 v[128:131], v[192:195], v[44:47], v[128:131]
    v_mfma_f32_16x16x32_bf16 v[132:135], v[196:199], v[44:47], v[132:135]
    v_exp_f32 v25, v25
    v_mfma_f32_16x16x32_bf16 a[72:75], v[200:203], v[44:47], a[72:75]
    s_add_u32 m0, s34, 0
    v_cvt_pk_bf16_f32 v40, v24, v25
    v_mfma_f32_16x16x32_bf16 a[76:79], v[204:207], v[44:47], a[76:79]
    v_exp_f32 v26, v26
    v_mfma_f32_16x16x32_bf16 a[80:83], v[208:211], v[44:47], a[80:83]
    v_mfma_f32_16x16x32_bf16 a[84:87], v[212:215], v[44:47], a[84:87]
    v_exp_f32 v27, v27
    v_mfma_f32_16x16x32_bf16 a[88:91], v[248:251], v[44:47], a[88:91]
    v_cvt_pk_bf16_f32 v41, v26, v27
    v_mfma_f32_16x16x32_bf16 a[92:95], v[252:255], v[44:47], a[92:95]
    v_exp_f32 v28, v28
    v_mfma_f32_16x16x32_bf16 v[88:91], v[20:23], v[44:47], v[88:91]
    buffer_load_dwordx4 v4, s[16:19], s72 offen lds
    v_mfma_f32_16x16x32_bf16 v[32:35], v[160:163], a[248:251], v[68:71]
    v_exp_f32 v29, v29
    v_mfma_f32_16x16x32_bf16 v[32:35], v[164:167], a[252:255], v[32:35]
    v_cvt_pk_bf16_f32 v42, v28, v29
    v_mfma_f32_16x16x32_bf16 v[32:35], v[168:171], v[224:227], v[32:35]
    v_exp_f32 v30, v30
    v_mfma_f32_16x16x32_bf16 v[32:35], v[172:175], v[228:231], v[32:35]
    buffer_load_dwordx4 v5, s[16:19], s72 offen offset:1024 lds
    v_mfma_f32_16x16x32_bf16 v[36:39], v[176:179], a[248:251], v[68:71]
    v_exp_f32 v31, v31
    v_mfma_f32_16x16x32_bf16 v[36:39], v[180:183], a[252:255], v[36:39]
    s_add_u32 m0, s34, 16384
    v_cvt_pk_bf16_f32 v43, v30, v31
    v_mfma_f32_16x16x32_bf16 v[36:39], v[184:187], v[224:227], v[36:39]
    buffer_load_dwordx4 v8, s[20:23], s72 offen lds
    v_mfma_f32_16x16x32_bf16 v[36:39], v[188:191], v[228:231], v[36:39]
    v_exp_f32 v32, v32
    v_mfma_f32_16x16x32_bf16 v[136:139], v[192:195], v[40:43], v[136:139]
    v_mfma_f32_16x16x32_bf16 v[140:143], v[196:199], v[40:43], v[140:143]
    v_exp_f32 v33, v33
    v_mfma_f32_16x16x32_bf16 a[96:99], v[200:203], v[40:43], a[96:99]
    v_cvt_pk_bf16_f32 v44, v32, v33
    v_mfma_f32_16x16x32_bf16 a[100:103], v[204:207], v[40:43], a[100:103]
    v_exp_f32 v34, v34
    v_mfma_f32_16x16x32_bf16 a[104:107], v[208:211], v[40:43], a[104:107]
    buffer_load_dwordx4 v8, s[20:23], s72 offen offset:1024 lds
    v_mfma_f32_16x16x32_bf16 a[108:111], v[212:215], v[40:43], a[108:111]
    v_exp_f32 v35, v35
    v_mfma_f32_16x16x32_bf16 a[112:115], v[248:251], v[40:43], a[112:115]
    v_cvt_pk_bf16_f32 v45, v34, v35
    v_mfma_f32_16x16x32_bf16 a[116:119], v[252:255], v[40:43], a[116:119]
    v_exp_f32 v36, v36
    v_mfma_f32_16x16x32_bf16 v[92:95], v[20:23], v[40:43], v[92:95]
    s_waitcnt vmcnt(10)
    v_mfma_f32_16x16x32_bf16 v[24:27], v[160:163], v[232:235], v[72:75]
    v_exp_f32 v37, v37
    v_mfma_f32_16x16x32_bf16 v[24:27], v[164:167], v[236:239], v[24:27]
    ds_read_b128 v[160:163], v9 offset:8192
    v_cvt_pk_bf16_f32 v46, v36, v37
    v_mfma_f32_16x16x32_bf16 v[24:27], v[168:171], v[240:243], v[24:27]
    v_exp_f32 v38, v38
    v_mfma_f32_16x16x32_bf16 v[24:27], v[172:175], v[244:247], v[24:27]
    ds_read_b128 v[164:167], v10 offset:8192
    ds_read_b128 v[168:171], v11 offset:8192
    v_mfma_f32_16x16x32_bf16 v[28:31], v[176:179], v[232:235], v[72:75]
    v_exp_f32 v39, v39
    v_mfma_f32_16x16x32_bf16 v[28:31], v[180:183], v[236:239], v[28:31]
    ds_read_b128 v[172:175], v12 offset:8192
    v_cvt_pk_bf16_f32 v47, v38, v39
    v_mfma_f32_16x16x32_bf16 v[28:31], v[184:187], v[240:243], v[28:31]
    ds_read_b128 v[176:179], v9 offset:12288
    ds_read_b128 v[180:183], v10 offset:12288
    v_mfma_f32_16x16x32_bf16 v[28:31], v[188:191], v[244:247], v[28:31]
    v_exp_f32 v24, v24
    v_mfma_f32_16x16x32_bf16 v[144:147], v[192:195], v[44:47], v[144:147]
    ds_read_b128 v[184:187], v11 offset:12288
    ds_read_b128 v[188:191], v12 offset:12288
    v_mfma_f32_16x16x32_bf16 v[148:151], v[196:199], v[44:47], v[148:151]
    v_exp_f32 v25, v25
    v_mfma_f32_16x16x32_bf16 a[120:123], v[200:203], v[44:47], a[120:123]
    s_add_u32 m0, s34, 2048
    v_cvt_pk_bf16_f32 v40, v24, v25
    v_mfma_f32_16x16x32_bf16 a[124:127], v[204:207], v[44:47], a[124:127]
    v_exp_f32 v26, v26
    v_mfma_f32_16x16x32_bf16 a[128:131], v[208:211], v[44:47], a[128:131]
    s_waitcnt vmcnt(4)
    v_mfma_f32_16x16x32_bf16 a[132:135], v[212:215], v[44:47], a[132:135]
    v_exp_f32 v27, v27
    v_mfma_f32_16x16x32_bf16 a[136:139], v[248:251], v[44:47], a[136:139]
    ds_read_b64_tr_b16 v[216:217], v16 offset:8192
    v_cvt_pk_bf16_f32 v41, v26, v27
    v_mfma_f32_16x16x32_bf16 a[140:143], v[252:255], v[44:47], a[140:143]
    v_exp_f32 v28, v28
    v_mfma_f32_16x16x32_bf16 v[96:99], v[20:23], v[44:47], v[96:99]
    s_waitcnt lgkmcnt(1)
    ds_read_b64_tr_b16 v[218:219], v16 offset:12288
    v_mfma_f32_16x16x32_bf16 v[32:35], v[160:163], a[168:171], v[48:51]
    v_exp_f32 v29, v29
    v_mfma_f32_16x16x32_bf16 v[32:35], v[164:167], a[172:175], v[32:35]
    ds_read_b64_tr_b16 v[220:221], v16 offset:8200
    v_cvt_pk_bf16_f32 v42, v28, v29
    v_mfma_f32_16x16x32_bf16 v[32:35], v[168:171], a[176:179], v[32:35]
    v_exp_f32 v30, v30
    v_mfma_f32_16x16x32_bf16 v[32:35], v[172:175], a[180:183], v[32:35]
    ds_read_b64_tr_b16 v[222:223], v16 offset:12296
    v_mfma_f32_16x16x32_bf16 v[36:39], v[176:179], a[168:171], v[48:51]
    v_exp_f32 v31, v31
    v_mfma_f32_16x16x32_bf16 v[36:39], v[180:183], a[172:175], v[36:39]
    v_cvt_pk_bf16_f32 v43, v30, v31
    v_mfma_f32_16x16x32_bf16 v[36:39], v[184:187], a[176:179], v[36:39]
    buffer_load_dwordx4 v6, s[16:19], s73 offen lds
    v_mfma_f32_16x16x32_bf16 v[36:39], v[188:191], a[180:183], v[36:39]
    v_exp_f32 v32, v32
    v_mfma_f32_16x16x32_bf16 v[152:155], v[192:195], v[40:43], v[152:155]
    ds_read_b64_tr_b16 v[192:193], v13 offset:8192
    ds_read_b64_tr_b16 v[194:195], v13 offset:12288
    v_mfma_f32_16x16x32_bf16 v[156:159], v[196:199], v[40:43], v[156:159]
    v_exp_f32 v33, v33
    v_mfma_f32_16x16x32_bf16 a[144:147], v[200:203], v[40:43], a[144:147]
    ds_read_b64_tr_b16 v[196:197], v13 offset:8200
    v_cvt_pk_bf16_f32 v44, v32, v33
    v_mfma_f32_16x16x32_bf16 a[148:151], v[204:207], v[40:43], a[148:151]
    v_exp_f32 v34, v34
    v_mfma_f32_16x16x32_bf16 a[152:155], v[208:211], v[40:43], a[152:155]
    ds_read_b64_tr_b16 v[198:199], v13 offset:12296
    ds_read_b64_tr_b16 v[200:201], v14 offset:8192
    v_mfma_f32_16x16x32_bf16 a[156:159], v[212:215], v[40:43], a[156:159]
    v_exp_f32 v35, v35
    v_mfma_f32_16x16x32_bf16 a[160:163], v[248:251], v[40:43], a[160:163]
    ds_read_b64_tr_b16 v[202:203], v14 offset:12288
    v_cvt_pk_bf16_f32 v45, v34, v35
    v_mfma_f32_16x16x32_bf16 a[164:167], v[252:255], v[40:43], a[164:167]
    v_exp_f32 v36, v36
    v_mfma_f32_16x16x32_bf16 v[100:103], v[20:23], v[40:43], v[100:103]
    ds_read_b64_tr_b16 v[204:205], v14 offset:8200
    ds_read_b64_tr_b16 v[206:207], v14 offset:12296
    v_mfma_f32_16x16x32_bf16 v[24:27], v[160:163], a[184:187], v[52:55]
    v_exp_f32 v37, v37
    v_mfma_f32_16x16x32_bf16 v[24:27], v[164:167], a[188:191], v[24:27]
    ds_read_b64_tr_b16 v[208:209], v15 offset:8192
    v_cvt_pk_bf16_f32 v46, v36, v37
    v_mfma_f32_16x16x32_bf16 v[24:27], v[168:171], a[192:195], v[24:27]
    v_exp_f32 v38, v38
    v_mfma_f32_16x16x32_bf16 v[24:27], v[172:175], a[196:199], v[24:27]
    ds_read_b64_tr_b16 v[210:211], v15 offset:12288
    ds_read_b64_tr_b16 v[212:213], v15 offset:8200
    v_mfma_f32_16x16x32_bf16 v[28:31], v[176:179], a[184:187], v[52:55]
    v_exp_f32 v39, v39
    v_mfma_f32_16x16x32_bf16 v[28:31], v[180:183], a[188:191], v[28:31]
    ds_read_b64_tr_b16 v[214:215], v15 offset:12296
    v_cvt_pk_bf16_f32 v47, v38, v39
    v_mfma_f32_16x16x32_bf16 v[28:31], v[184:187], a[192:195], v[28:31]
    s_waitcnt lgkmcnt(6)
    v_mfma_f32_16x16x32_bf16 v[28:31], v[188:191], a[196:199], v[28:31]
    v_exp_f32 v24, v24
    v_mfma_f32_16x16x32_bf16 v[104:107], v[192:195], v[44:47], v[104:107]
    buffer_load_dwordx4 v7, s[16:19], s73 offen offset:1024 lds
    v_mfma_f32_16x16x32_bf16 v[108:111], v[196:199], v[44:47], v[108:111]
    v_exp_f32 v25, v25
    v_mfma_f32_16x16x32_bf16 a[0:3], v[200:203], v[44:47], a[0:3]
    s_waitcnt lgkmcnt(0)
    v_cvt_pk_bf16_f32 v40, v24, v25
    v_mfma_f32_16x16x32_bf16 a[4:7], v[204:207], v[44:47], a[4:7]
    v_exp_f32 v26, v26
    v_mfma_f32_16x16x32_bf16 a[8:11], v[208:211], v[44:47], a[8:11]
    v_mfma_f32_16x16x32_bf16 a[12:15], v[212:215], v[44:47], a[12:15]
    v_exp_f32 v27, v27
    v_mfma_f32_16x16x32_bf16 a[16:19], v[216:219], v[44:47], a[16:19]
    s_add_u32 m0, s34, 4096
    v_cvt_pk_bf16_f32 v41, v26, v27
    v_mfma_f32_16x16x32_bf16 a[20:23], v[220:223], v[44:47], a[20:23]
    v_exp_f32 v28, v28
    v_mfma_f32_16x16x32_bf16 v[76:79], v[20:23], v[44:47], v[76:79]
    buffer_load_dwordx4 v4, s[16:19], s74 offen lds
    v_mfma_f32_16x16x32_bf16 v[32:35], v[160:163], a[200:203], v[56:59]
    v_exp_f32 v29, v29
    v_mfma_f32_16x16x32_bf16 v[32:35], v[164:167], a[204:207], v[32:35]
    v_cvt_pk_bf16_f32 v42, v28, v29
    v_mfma_f32_16x16x32_bf16 v[32:35], v[168:171], a[208:211], v[32:35]
    v_exp_f32 v30, v30
    v_mfma_f32_16x16x32_bf16 v[32:35], v[172:175], a[212:215], v[32:35]
    buffer_load_dwordx4 v5, s[16:19], s74 offen offset:1024 lds
    v_mfma_f32_16x16x32_bf16 v[36:39], v[176:179], a[200:203], v[56:59]
    v_exp_f32 v31, v31
    v_mfma_f32_16x16x32_bf16 v[36:39], v[180:183], a[204:207], v[36:39]
    v_cvt_pk_bf16_f32 v43, v30, v31
    v_mfma_f32_16x16x32_bf16 v[36:39], v[184:187], a[208:211], v[36:39]
    buffer_load_dwordx4 v6, s[16:19], s74 offen offset:2048 lds
    v_mfma_f32_16x16x32_bf16 v[36:39], v[188:191], a[212:215], v[36:39]
    v_exp_f32 v32, v32
    v_mfma_f32_16x16x32_bf16 v[112:115], v[192:195], v[40:43], v[112:115]
    buffer_load_dwordx4 v7, s[16:19], s74 offen offset:3072 lds
    v_mfma_f32_16x16x32_bf16 v[116:119], v[196:199], v[40:43], v[116:119]
    v_exp_f32 v33, v33
    v_mfma_f32_16x16x32_bf16 a[24:27], v[200:203], v[40:43], a[24:27]
    s_add_u32 m0, s34, 18432
    v_cvt_pk_bf16_f32 v44, v32, v33
    v_mfma_f32_16x16x32_bf16 a[28:31], v[204:207], v[40:43], a[28:31]
    v_exp_f32 v34, v34
    v_mfma_f32_16x16x32_bf16 a[32:35], v[208:211], v[40:43], a[32:35]
    buffer_load_dwordx4 v8, s[20:23], s73 offen lds
    v_mfma_f32_16x16x32_bf16 a[36:39], v[212:215], v[40:43], a[36:39]
    v_exp_f32 v35, v35
    v_mfma_f32_16x16x32_bf16 a[40:43], v[216:219], v[40:43], a[40:43]
    v_cvt_pk_bf16_f32 v45, v34, v35
    v_mfma_f32_16x16x32_bf16 a[44:47], v[220:223], v[40:43], a[44:47]
    v_exp_f32 v36, v36
    v_mfma_f32_16x16x32_bf16 v[80:83], v[20:23], v[40:43], v[80:83]
    buffer_load_dwordx4 v8, s[20:23], s73 offen offset:1024 lds
    v_mfma_f32_16x16x32_bf16 v[24:27], v[160:163], a[216:219], v[60:63]
    v_exp_f32 v37, v37
    v_mfma_f32_16x16x32_bf16 v[24:27], v[164:167], a[220:223], v[24:27]
    s_add_u32 m0, s34, 20480
    v_cvt_pk_bf16_f32 v46, v36, v37
    v_mfma_f32_16x16x32_bf16 v[24:27], v[168:171], a[224:227], v[24:27]
    v_exp_f32 v38, v38
    v_mfma_f32_16x16x32_bf16 v[24:27], v[172:175], a[228:231], v[24:27]
    buffer_load_dwordx4 v8, s[20:23], s74 offen lds
    v_mfma_f32_16x16x32_bf16 v[28:31], v[176:179], a[216:219], v[60:63]
    v_exp_f32 v39, v39
    v_mfma_f32_16x16x32_bf16 v[28:31], v[180:183], a[220:223], v[28:31]
    v_cvt_pk_bf16_f32 v47, v38, v39
    v_mfma_f32_16x16x32_bf16 v[28:31], v[184:187], a[224:227], v[28:31]
    buffer_load_dwordx4 v8, s[20:23], s74 offen offset:1024 lds
    v_mfma_f32_16x16x32_bf16 v[28:31], v[188:191], a[228:231], v[28:31]
    v_exp_f32 v24, v24
    v_mfma_f32_16x16x32_bf16 v[120:123], v[192:195], v[44:47], v[120:123]
    v_mfma_f32_16x16x32_bf16 v[124:127], v[196:199], v[44:47], v[124:127]
    v_exp_f32 v25, v25
    v_mfma_f32_16x16x32_bf16 a[48:51], v[200:203], v[44:47], a[48:51]
    v_cvt_pk_bf16_f32 v40, v24, v25
    v_mfma_f32_16x16x32_bf16 a[52:55], v[204:207], v[44:47], a[52:55]
    v_exp_f32 v26, v26
    v_mfma_f32_16x16x32_bf16 a[56:59], v[208:211], v[44:47], a[56:59]
    v_mfma_f32_16x16x32_bf16 a[60:63], v[212:215], v[44:47], a[60:63]
    v_exp_f32 v27, v27
    v_mfma_f32_16x16x32_bf16 a[64:67], v[216:219], v[44:47], a[64:67]
    v_cvt_pk_bf16_f32 v41, v26, v27
    v_mfma_f32_16x16x32_bf16 a[68:71], v[220:223], v[44:47], a[68:71]
    v_exp_f32 v28, v28
    v_mfma_f32_16x16x32_bf16 v[84:87], v[20:23], v[44:47], v[84:87]
    buffer_load_dwordx4 v8, s[20:23], s74 offen offset:2048 lds
    v_mfma_f32_16x16x32_bf16 v[32:35], v[160:163], a[232:235], v[64:67]
    v_exp_f32 v29, v29
    v_mfma_f32_16x16x32_bf16 v[32:35], v[164:167], a[236:239], v[32:35]
    v_cvt_pk_bf16_f32 v42, v28, v29
    v_mfma_f32_16x16x32_bf16 v[32:35], v[168:171], a[240:243], v[32:35]
    v_exp_f32 v30, v30
    v_mfma_f32_16x16x32_bf16 v[32:35], v[172:175], a[244:247], v[32:35]
    buffer_load_dwordx4 v8, s[20:23], s74 offen offset:3072 lds
    v_mfma_f32_16x16x32_bf16 v[36:39], v[176:179], a[232:235], v[64:67]
    v_exp_f32 v31, v31
    v_mfma_f32_16x16x32_bf16 v[36:39], v[180:183], a[236:239], v[36:39]
    s_nop 0
    v_cvt_pk_bf16_f32 v43, v30, v31
    v_mfma_f32_16x16x32_bf16 v[36:39], v[184:187], a[240:243], v[36:39]
    v_mfma_f32_16x16x32_bf16 v[36:39], v[188:191], a[244:247], v[36:39]
    v_exp_f32 v32, v32
    v_mfma_f32_16x16x32_bf16 v[128:131], v[192:195], v[40:43], v[128:131]
    v_mfma_f32_16x16x32_bf16 v[132:135], v[196:199], v[40:43], v[132:135]
    v_exp_f32 v33, v33
    v_mfma_f32_16x16x32_bf16 a[72:75], v[200:203], v[40:43], a[72:75]
    s_add_u32 m0, s34, 8192
    v_cvt_pk_bf16_f32 v44, v32, v33
    v_mfma_f32_16x16x32_bf16 a[76:79], v[204:207], v[40:43], a[76:79]
    v_exp_f32 v34, v34
    v_mfma_f32_16x16x32_bf16 a[80:83], v[208:211], v[40:43], a[80:83]
    v_mfma_f32_16x16x32_bf16 a[84:87], v[212:215], v[40:43], a[84:87]
    v_exp_f32 v35, v35
    v_mfma_f32_16x16x32_bf16 a[88:91], v[216:219], v[40:43], a[88:91]
    v_cvt_pk_bf16_f32 v45, v34, v35
    v_mfma_f32_16x16x32_bf16 a[92:95], v[220:223], v[40:43], a[92:95]
    v_exp_f32 v36, v36
    v_mfma_f32_16x16x32_bf16 v[88:91], v[20:23], v[40:43], v[88:91]
    buffer_load_dwordx4 v4, s[16:19], s76 offen lds
    v_mfma_f32_16x16x32_bf16 v[24:27], v[160:163], a[248:251], v[68:71]
    v_exp_f32 v37, v37
    v_mfma_f32_16x16x32_bf16 v[24:27], v[164:167], a[252:255], v[24:27]
    v_cvt_pk_bf16_f32 v46, v36, v37
    v_mfma_f32_16x16x32_bf16 v[24:27], v[168:171], v[224:227], v[24:27]
    v_exp_f32 v38, v38
    v_mfma_f32_16x16x32_bf16 v[24:27], v[172:175], v[228:231], v[24:27]
    buffer_load_dwordx4 v5, s[16:19], s76 offen offset:1024 lds
    v_mfma_f32_16x16x32_bf16 v[28:31], v[176:179], a[248:251], v[68:71]
    v_exp_f32 v39, v39
    v_mfma_f32_16x16x32_bf16 v[28:31], v[180:183], a[252:255], v[28:31]
    s_add_u32 m0, s34, 24576
    v_cvt_pk_bf16_f32 v47, v38, v39
    v_mfma_f32_16x16x32_bf16 v[28:31], v[184:187], v[224:227], v[28:31]
    buffer_load_dwordx4 v8, s[20:23], s76 offen lds
    v_mfma_f32_16x16x32_bf16 v[28:31], v[188:191], v[228:231], v[28:31]
    v_exp_f32 v24, v24
    v_mfma_f32_16x16x32_bf16 v[136:139], v[192:195], v[44:47], v[136:139]
    v_mfma_f32_16x16x32_bf16 v[140:143], v[196:199], v[44:47], v[140:143]
    v_exp_f32 v25, v25
    v_mfma_f32_16x16x32_bf16 a[96:99], v[200:203], v[44:47], a[96:99]
    v_cvt_pk_bf16_f32 v40, v24, v25
    v_mfma_f32_16x16x32_bf16 a[100:103], v[204:207], v[44:47], a[100:103]
    v_exp_f32 v26, v26
    v_mfma_f32_16x16x32_bf16 a[104:107], v[208:211], v[44:47], a[104:107]
    buffer_load_dwordx4 v8, s[20:23], s76 offen offset:1024 lds
    v_mfma_f32_16x16x32_bf16 a[108:111], v[212:215], v[44:47], a[108:111]
    v_exp_f32 v27, v27
    v_mfma_f32_16x16x32_bf16 a[112:115], v[216:219], v[44:47], a[112:115]
    v_cvt_pk_bf16_f32 v41, v26, v27
    v_mfma_f32_16x16x32_bf16 a[116:119], v[220:223], v[44:47], a[116:119]
    v_exp_f32 v28, v28
    v_mfma_f32_16x16x32_bf16 v[92:95], v[20:23], v[44:47], v[92:95]
    s_waitcnt vmcnt(10)
    v_mfma_f32_16x16x32_bf16 v[32:35], v[160:163], v[232:235], v[72:75]
    v_exp_f32 v29, v29
    v_mfma_f32_16x16x32_bf16 v[32:35], v[164:167], v[236:239], v[32:35]
    ds_read_b128 v[160:163], v9 offset:0
    v_cvt_pk_bf16_f32 v42, v28, v29
    v_mfma_f32_16x16x32_bf16 v[32:35], v[168:171], v[240:243], v[32:35]
    v_exp_f32 v30, v30
    v_mfma_f32_16x16x32_bf16 v[32:35], v[172:175], v[244:247], v[32:35]
    ds_read_b128 v[164:167], v10 offset:0
    ds_read_b128 v[168:171], v11 offset:0
    v_mfma_f32_16x16x32_bf16 v[36:39], v[176:179], v[232:235], v[72:75]
    v_exp_f32 v31, v31
    v_mfma_f32_16x16x32_bf16 v[36:39], v[180:183], v[236:239], v[36:39]
    ds_read_b128 v[172:175], v12 offset:0
    v_cvt_pk_bf16_f32 v43, v30, v31
    v_mfma_f32_16x16x32_bf16 v[36:39], v[184:187], v[240:243], v[36:39]
    ds_read_b128 v[176:179], v9 offset:4096
    ds_read_b128 v[180:183], v10 offset:4096
    v_mfma_f32_16x16x32_bf16 v[36:39], v[188:191], v[244:247], v[36:39]
    v_exp_f32 v32, v32
    v_mfma_f32_16x16x32_bf16 v[144:147], v[192:195], v[40:43], v[144:147]
    ds_read_b128 v[184:187], v11 offset:4096
    ds_read_b128 v[188:191], v12 offset:4096
    v_mfma_f32_16x16x32_bf16 v[148:151], v[196:199], v[40:43], v[148:151]
    v_exp_f32 v33, v33
    v_mfma_f32_16x16x32_bf16 a[120:123], v[200:203], v[40:43], a[120:123]
    s_add_u32 m0, s34, 10240
    v_cvt_pk_bf16_f32 v44, v32, v33
    v_mfma_f32_16x16x32_bf16 a[124:127], v[204:207], v[40:43], a[124:127]
    v_exp_f32 v34, v34
    v_mfma_f32_16x16x32_bf16 a[128:131], v[208:211], v[40:43], a[128:131]
    s_waitcnt vmcnt(4)
    v_mfma_f32_16x16x32_bf16 a[132:135], v[212:215], v[40:43], a[132:135]
    v_exp_f32 v35, v35
    v_mfma_f32_16x16x32_bf16 a[136:139], v[216:219], v[40:43], a[136:139]
    ds_read_b64_tr_b16 v[248:249], v16 offset:0
    v_cvt_pk_bf16_f32 v45, v34, v35
    v_mfma_f32_16x16x32_bf16 a[140:143], v[220:223], v[40:43], a[140:143]
    v_exp_f32 v36, v36
    v_mfma_f32_16x16x32_bf16 v[96:99], v[20:23], v[40:43], v[96:99]
    s_waitcnt lgkmcnt(1)
    ds_read_b64_tr_b16 v[250:251], v16 offset:4096
    v_mfma_f32_16x16x32_bf16 v[24:27], v[160:163], a[168:171], v[48:51]
    v_exp_f32 v37, v37
    v_mfma_f32_16x16x32_bf16 v[24:27], v[164:167], a[172:175], v[24:27]
    ds_read_b64_tr_b16 v[252:253], v16 offset:8
    v_cvt_pk_bf16_f32 v46, v36, v37
    v_mfma_f32_16x16x32_bf16 v[24:27], v[168:171], a[176:179], v[24:27]
    v_exp_f32 v38, v38
    v_mfma_f32_16x16x32_bf16 v[24:27], v[172:175], a[180:183], v[24:27]
    ds_read_b64_tr_b16 v[254:255], v16 offset:4104
    v_mfma_f32_16x16x32_bf16 v[28:31], v[176:179], a[168:171], v[48:51]
    v_exp_f32 v39, v39
    v_mfma_f32_16x16x32_bf16 v[28:31], v[180:183], a[172:175], v[28:31]
    v_cvt_pk_bf16_f32 v47, v38, v39
    v_mfma_f32_16x16x32_bf16 v[28:31], v[184:187], a[176:179], v[28:31]
    buffer_load_dwordx4 v6, s[16:19], s77 offen lds
    v_mfma_f32_16x16x32_bf16 v[28:31], v[188:191], a[180:183], v[28:31]
    v_exp_f32 v24, v24
    v_mfma_f32_16x16x32_bf16 v[152:155], v[192:195], v[44:47], v[152:155]
    ds_read_b64_tr_b16 v[192:193], v13 offset:0
    ds_read_b64_tr_b16 v[194:195], v13 offset:4096
    v_mfma_f32_16x16x32_bf16 v[156:159], v[196:199], v[44:47], v[156:159]
    v_exp_f32 v25, v25
    v_mfma_f32_16x16x32_bf16 a[144:147], v[200:203], v[44:47], a[144:147]
    ds_read_b64_tr_b16 v[196:197], v13 offset:8
    v_cvt_pk_bf16_f32 v40, v24, v25
    v_mfma_f32_16x16x32_bf16 a[148:151], v[204:207], v[44:47], a[148:151]
    v_exp_f32 v26, v26
    v_mfma_f32_16x16x32_bf16 a[152:155], v[208:211], v[44:47], a[152:155]
    ds_read_b64_tr_b16 v[198:199], v13 offset:4104
    ds_read_b64_tr_b16 v[200:201], v14 offset:0
    v_mfma_f32_16x16x32_bf16 a[156:159], v[212:215], v[44:47], a[156:159]
    v_exp_f32 v27, v27
    v_mfma_f32_16x16x32_bf16 a[160:163], v[216:219], v[44:47], a[160:163]
    ds_read_b64_tr_b16 v[202:203], v14 offset:4096
    v_cvt_pk_bf16_f32 v41, v26, v27
    v_mfma_f32_16x16x32_bf16 a[164:167], v[220:223], v[44:47], a[164:167]
    v_exp_f32 v28, v28
    v_mfma_f32_16x16x32_bf16 v[100:103], v[20:23], v[44:47], v[100:103]
    ds_read_b64_tr_b16 v[204:205], v14 offset:8
    ds_read_b64_tr_b16 v[206:207], v14 offset:4104
    v_mfma_f32_16x16x32_bf16 v[32:35], v[160:163], a[184:187], v[52:55]
    v_exp_f32 v29, v29
    v_mfma_f32_16x16x32_bf16 v[32:35], v[164:167], a[188:191], v[32:35]
    ds_read_b64_tr_b16 v[208:209], v15 offset:0
    v_cvt_pk_bf16_f32 v42, v28, v29
    v_mfma_f32_16x16x32_bf16 v[32:35], v[168:171], a[192:195], v[32:35]
    v_exp_f32 v30, v30
    v_mfma_f32_16x16x32_bf16 v[32:35], v[172:175], a[196:199], v[32:35]
    ds_read_b64_tr_b16 v[210:211], v15 offset:4096
    ds_read_b64_tr_b16 v[212:213], v15 offset:8
    v_mfma_f32_16x16x32_bf16 v[36:39], v[176:179], a[184:187], v[52:55]
    v_exp_f32 v31, v31
    v_mfma_f32_16x16x32_bf16 v[36:39], v[180:183], a[188:191], v[36:39]
    ds_read_b64_tr_b16 v[214:215], v15 offset:4104
    v_cvt_pk_bf16_f32 v43, v30, v31
    v_mfma_f32_16x16x32_bf16 v[36:39], v[184:187], a[192:195], v[36:39]
    s_waitcnt lgkmcnt(6)
    v_mfma_f32_16x16x32_bf16 v[36:39], v[188:191], a[196:199], v[36:39]
    v_exp_f32 v32, v32
    v_mfma_f32_16x16x32_bf16 v[104:107], v[192:195], v[40:43], v[104:107]
    buffer_load_dwordx4 v7, s[16:19], s77 offen offset:1024 lds
    v_mfma_f32_16x16x32_bf16 v[108:111], v[196:199], v[40:43], v[108:111]
    v_exp_f32 v33, v33
    v_mfma_f32_16x16x32_bf16 a[0:3], v[200:203], v[40:43], a[0:3]
    s_waitcnt lgkmcnt(0)
    v_cvt_pk_bf16_f32 v44, v32, v33
    v_mfma_f32_16x16x32_bf16 a[4:7], v[204:207], v[40:43], a[4:7]
    v_exp_f32 v34, v34
    v_mfma_f32_16x16x32_bf16 a[8:11], v[208:211], v[40:43], a[8:11]
    v_mfma_f32_16x16x32_bf16 a[12:15], v[212:215], v[40:43], a[12:15]
    v_exp_f32 v35, v35
    v_mfma_f32_16x16x32_bf16 a[16:19], v[248:251], v[40:43], a[16:19]
    s_add_u32 m0, s34, 12288
    v_cvt_pk_bf16_f32 v45, v34, v35
    v_mfma_f32_16x16x32_bf16 a[20:23], v[252:255], v[40:43], a[20:23]
    v_exp_f32 v36, v36
    v_mfma_f32_16x16x32_bf16 v[76:79], v[20:23], v[40:43], v[76:79]
    buffer_load_dwordx4 v4, s[16:19], s78 offen lds
    v_mfma_f32_16x16x32_bf16 v[24:27], v[160:163], a[200:203], v[56:59]
    v_exp_f32 v37, v37
    v_mfma_f32_16x16x32_bf16 v[24:27], v[164:167], a[204:207], v[24:27]
    s_sub_u32 s29, s28, 1
    v_cvt_pk_bf16_f32 v46, v36, v37
    v_mfma_f32_16x16x32_bf16 v[24:27], v[168:171], a[208:211], v[24:27]
    v_exp_f32 v38, v38
    v_mfma_f32_16x16x32_bf16 v[24:27], v[172:175], a[212:215], v[24:27]
    buffer_load_dwordx4 v5, s[16:19], s78 offen offset:1024 lds
    v_mfma_f32_16x16x32_bf16 v[28:31], v[176:179], a[200:203], v[56:59]
    v_exp_f32 v39, v39
    v_mfma_f32_16x16x32_bf16 v[28:31], v[180:183], a[204:207], v[28:31]
    s_and_b32 s29, s29, 3
    v_cvt_pk_bf16_f32 v47, v38, v39
    v_mfma_f32_16x16x32_bf16 v[28:31], v[184:187], a[208:211], v[28:31]
    buffer_load_dwordx4 v6, s[16:19], s78 offen offset:2048 lds
    v_mfma_f32_16x16x32_bf16 v[28:31], v[188:191], a[212:215], v[28:31]
    v_exp_f32 v24, v24
    v_mfma_f32_16x16x32_bf16 v[112:115], v[192:195], v[44:47], v[112:115]
    buffer_load_dwordx4 v7, s[16:19], s78 offen offset:3072 lds
    v_mfma_f32_16x16x32_bf16 v[116:119], v[196:199], v[44:47], v[116:119]
    v_exp_f32 v25, v25
    v_mfma_f32_16x16x32_bf16 a[24:27], v[200:203], v[44:47], a[24:27]
    s_add_u32 m0, s34, 26624
    v_cvt_pk_bf16_f32 v40, v24, v25
    v_mfma_f32_16x16x32_bf16 a[28:31], v[204:207], v[44:47], a[28:31]
    v_exp_f32 v26, v26
    v_mfma_f32_16x16x32_bf16 a[32:35], v[208:211], v[44:47], a[32:35]
    buffer_load_dwordx4 v8, s[20:23], s77 offen lds
    v_mfma_f32_16x16x32_bf16 a[36:39], v[212:215], v[44:47], a[36:39]
    v_exp_f32 v27, v27
    v_mfma_f32_16x16x32_bf16 a[40:43], v[248:251], v[44:47], a[40:43]
    s_mul_i32 s29, s29, 40960
    v_cvt_pk_bf16_f32 v41, v26, v27
    v_mfma_f32_16x16x32_bf16 a[44:47], v[252:255], v[44:47], a[44:47]
    v_exp_f32 v28, v28
    v_mfma_f32_16x16x32_bf16 v[80:83], v[20:23], v[44:47], v[80:83]
    buffer_load_dwordx4 v8, s[20:23], s77 offen offset:1024 lds
    v_mfma_f32_16x16x32_bf16 v[32:35], v[160:163], a[216:219], v[60:63]
    v_exp_f32 v29, v29
    v_mfma_f32_16x16x32_bf16 v[32:35], v[164:167], a[220:223], v[32:35]
    s_add_u32 m0, s34, 28672
    v_cvt_pk_bf16_f32 v42, v28, v29
    v_mfma_f32_16x16x32_bf16 v[32:35], v[168:171], a[224:227], v[32:35]
    v_exp_f32 v30, v30
    v_mfma_f32_16x16x32_bf16 v[32:35], v[172:175], a[228:231], v[32:35]
    buffer_load_dwordx4 v8, s[20:23], s78 offen lds
    v_mfma_f32_16x16x32_bf16 v[36:39], v[176:179], a[216:219], v[60:63]
    v_exp_f32 v31, v31
    v_mfma_f32_16x16x32_bf16 v[36:39], v[180:183], a[220:223], v[36:39]
    s_sub_u32 s30, s28, 2
    v_cvt_pk_bf16_f32 v43, v30, v31
    v_mfma_f32_16x16x32_bf16 v[36:39], v[184:187], a[224:227], v[36:39]
    buffer_load_dwordx4 v8, s[20:23], s78 offen offset:1024 lds
    v_mfma_f32_16x16x32_bf16 v[36:39], v[188:191], a[228:231], v[36:39]
    v_exp_f32 v32, v32
    v_mfma_f32_16x16x32_bf16 v[120:123], v[192:195], v[40:43], v[120:123]
    s_and_b32 s30, s30, 3
    s_mul_i32 s30, s30, 40960
    v_mfma_f32_16x16x32_bf16 v[124:127], v[196:199], v[40:43], v[124:127]
    v_exp_f32 v33, v33
    v_mfma_f32_16x16x32_bf16 a[48:51], v[200:203], v[40:43], a[48:51]
    s_sub_u32 s31, s28, 3
    v_cvt_pk_bf16_f32 v44, v32, v33
    v_mfma_f32_16x16x32_bf16 a[52:55], v[204:207], v[40:43], a[52:55]
    v_exp_f32 v34, v34
    v_mfma_f32_16x16x32_bf16 a[56:59], v[208:211], v[40:43], a[56:59]
    s_and_b32 s31, s31, 3
    s_mul_i32 s31, s31, 40960
    v_mfma_f32_16x16x32_bf16 a[60:63], v[212:215], v[40:43], a[60:63]
    v_exp_f32 v35, v35
    v_mfma_f32_16x16x32_bf16 a[64:67], v[248:251], v[40:43], a[64:67]
    s_lshl_b32 s39, s28, 6
    v_cvt_pk_bf16_f32 v45, v34, v35
    v_mfma_f32_16x16x32_bf16 a[68:71], v[252:255], v[40:43], a[68:71]
    v_exp_f32 v36, v36
    v_mfma_f32_16x16x32_bf16 v[84:87], v[20:23], v[40:43], v[84:87]
    buffer_load_dwordx4 v8, s[20:23], s78 offen offset:2048 lds
    v_mfma_f32_16x16x32_bf16 v[24:27], v[160:163], a[232:235], v[64:67]
    v_exp_f32 v37, v37
    v_mfma_f32_16x16x32_bf16 v[24:27], v[164:167], a[236:239], v[24:27]
    s_mov_b32 s48, 0
    v_cvt_pk_bf16_f32 v46, v36, v37
    v_mfma_f32_16x16x32_bf16 v[24:27], v[168:171], a[240:243], v[24:27]
    v_exp_f32 v38, v38
    v_mfma_f32_16x16x32_bf16 v[24:27], v[172:175], a[244:247], v[24:27]
    buffer_load_dwordx4 v8, s[20:23], s78 offen offset:3072 lds
    v_mfma_f32_16x16x32_bf16 v[28:31], v[176:179], a[232:235], v[64:67]
    v_exp_f32 v39, v39
    v_mfma_f32_16x16x32_bf16 v[28:31], v[180:183], a[236:239], v[28:31]
    s_mov_b32 s49, 4096
    v_cvt_pk_bf16_f32 v47, v38, v39
    v_mfma_f32_16x16x32_bf16 v[28:31], v[184:187], a[240:243], v[28:31]
    s_mov_b32 s50, 8192
    s_mov_b32 s51, 12288
    v_mfma_f32_16x16x32_bf16 v[28:31], v[188:191], a[244:247], v[28:31]
    v_exp_f32 v24, v24
    v_mfma_f32_16x16x32_bf16 v[128:131], v[192:195], v[44:47], v[128:131]
    s_mov_b32 s52, 16384
    s_mov_b32 s53, 20480
    v_mfma_f32_16x16x32_bf16 v[132:135], v[196:199], v[44:47], v[132:135]
    v_exp_f32 v25, v25
    v_mfma_f32_16x16x32_bf16 a[72:75], v[200:203], v[44:47], a[72:75]
    s_mov_b32 s54, 24576
    v_cvt_pk_bf16_f32 v40, v24, v25
    v_mfma_f32_16x16x32_bf16 a[76:79], v[204:207], v[44:47], a[76:79]
    v_exp_f32 v26, v26
    v_mfma_f32_16x16x32_bf16 a[80:83], v[208:211], v[44:47], a[80:83]
    v_lshlrev_b32 v3, 4, v0
    v_add_u32 v17, s29, v3
    v_mfma_f32_16x16x32_bf16 a[84:87], v[212:215], v[44:47], a[84:87]
    v_exp_f32 v27, v27
    v_mfma_f32_16x16x32_bf16 a[88:91], v[248:251], v[44:47], a[88:91]
    v_cvt_pk_bf16_f32 v41, v26, v27
    v_add_u32 v18, s30, v3
    v_mfma_f32_16x16x32_bf16 a[92:95], v[252:255], v[44:47], a[92:95]
    v_exp_f32 v28, v28
    v_mfma_f32_16x16x32_bf16 v[88:91], v[20:23], v[44:47], v[88:91]
    v_add_u32 v19, s31, v3
    v_and_b32 v2, 15, v0
    v_mfma_f32_16x16x32_bf16 v[32:35], v[160:163], a[248:251], v[68:71]
    v_exp_f32 v29, v29
    v_mfma_f32_16x16x32_bf16 v[32:35], v[164:167], a[252:255], v[32:35]
    v_cvt_pk_bf16_f32 v42, v28, v29
    v_lshlrev_b32 v2, 8, v2
    v_mfma_f32_16x16x32_bf16 v[32:35], v[168:171], v[224:227], v[32:35]
    v_exp_f32 v30, v30
    v_mfma_f32_16x16x32_bf16 v[32:35], v[172:175], v[228:231], v[32:35]
    v_and_b32 v3, 48, v0
    v_add3_u32 v2, v2, v3, s39
    v_mfma_f32_16x16x32_bf16 v[36:39], v[176:179], a[248:251], v[68:71]
    v_exp_f32 v31, v31
    v_mfma_f32_16x16x32_bf16 v[36:39], v[180:183], a[252:255], v[36:39]
    v_cvt_pk_bf16_f32 v43, v30, v31
    v_mfma_f32_16x16x32_bf16 v[36:39], v[184:187], v[224:227], v[36:39]
    v_mfma_f32_16x16x32_bf16 v[36:39], v[188:191], v[228:231], v[36:39]
    v_exp_f32 v32, v32
    v_mfma_f32_16x16x32_bf16 v[136:139], v[192:195], v[40:43], v[136:139]
    v_mfma_f32_16x16x32_bf16 v[140:143], v[196:199], v[40:43], v[140:143]
    v_exp_f32 v33, v33
    v_mfma_f32_16x16x32_bf16 a[96:99], v[200:203], v[40:43], a[96:99]
    v_cvt_pk_bf16_f32 v44, v32, v33
    v_mfma_f32_16x16x32_bf16 a[100:103], v[204:207], v[40:43], a[100:103]
    v_exp_f32 v34, v34
    v_mfma_f32_16x16x32_bf16 a[104:107], v[208:211], v[40:43], a[104:107]
    v_mfma_f32_16x16x32_bf16 a[108:111], v[212:215], v[40:43], a[108:111]
    v_exp_f32 v35, v35
    v_mfma_f32_16x16x32_bf16 a[112:115], v[248:251], v[40:43], a[112:115]
    v_cvt_pk_bf16_f32 v45, v34, v35
    v_mfma_f32_16x16x32_bf16 a[116:119], v[252:255], v[40:43], a[116:119]
    v_exp_f32 v36, v36
    v_mfma_f32_16x16x32_bf16 v[92:95], v[20:23], v[40:43], v[92:95]
    s_waitcnt vmcnt(6)
    v_mfma_f32_16x16x32_bf16 v[24:27], v[160:163], v[232:235], v[72:75]
    v_exp_f32 v37, v37
    v_mfma_f32_16x16x32_bf16 v[24:27], v[164:167], v[236:239], v[24:27]
    ds_read_b128 v[160:163], v9 offset:8192
    v_cvt_pk_bf16_f32 v46, v36, v37
    v_mfma_f32_16x16x32_bf16 v[24:27], v[168:171], v[240:243], v[24:27]
    v_exp_f32 v38, v38
    v_mfma_f32_16x16x32_bf16 v[24:27], v[172:175], v[244:247], v[24:27]
    ds_read_b128 v[164:167], v10 offset:8192
    ds_read_b128 v[168:171], v11 offset:8192
    v_mfma_f32_16x16x32_bf16 v[28:31], v[176:179], v[232:235], v[72:75]
    v_exp_f32 v39, v39
    v_mfma_f32_16x16x32_bf16 v[28:31], v[180:183], v[236:239], v[28:31]
    ds_read_b128 v[172:175], v12 offset:8192
    v_cvt_pk_bf16_f32 v47, v38, v39
    v_mfma_f32_16x16x32_bf16 v[28:31], v[184:187], v[240:243], v[28:31]
    ds_read_b128 v[176:179], v9 offset:12288
    ds_read_b128 v[180:183], v10 offset:12288
    v_mfma_f32_16x16x32_bf16 v[28:31], v[188:191], v[244:247], v[28:31]
    v_exp_f32 v24, v24
    v_mfma_f32_16x16x32_bf16 v[144:147], v[192:195], v[44:47], v[144:147]
    ds_read_b128 v[184:187], v11 offset:12288
    ds_read_b128 v[188:191], v12 offset:12288
    v_mfma_f32_16x16x32_bf16 v[148:151], v[196:199], v[44:47], v[148:151]
    v_exp_f32 v25, v25
    v_mfma_f32_16x16x32_bf16 a[120:123], v[200:203], v[44:47], a[120:123]
    v_cvt_pk_bf16_f32 v40, v24, v25
    v_mfma_f32_16x16x32_bf16 a[124:127], v[204:207], v[44:47], a[124:127]
    v_exp_f32 v26, v26
    v_mfma_f32_16x16x32_bf16 a[128:131], v[208:211], v[44:47], a[128:131]
    s_waitcnt vmcnt(0)
    v_mfma_f32_16x16x32_bf16 a[132:135], v[212:215], v[44:47], a[132:135]
    v_exp_f32 v27, v27
    v_mfma_f32_16x16x32_bf16 a[136:139], v[248:251], v[44:47], a[136:139]
    ds_read_b64_tr_b16 v[216:217], v16 offset:8192
    v_cvt_pk_bf16_f32 v41, v26, v27
    v_mfma_f32_16x16x32_bf16 a[140:143], v[252:255], v[44:47], a[140:143]
    v_exp_f32 v28, v28
    v_mfma_f32_16x16x32_bf16 v[96:99], v[20:23], v[44:47], v[96:99]
    s_waitcnt lgkmcnt(1)
    ds_read_b64_tr_b16 v[218:219], v16 offset:12288
    v_mfma_f32_16x16x32_bf16 v[32:35], v[160:163], a[168:171], v[48:51]
    v_exp_f32 v29, v29
    v_mfma_f32_16x16x32_bf16 v[32:35], v[164:167], a[172:175], v[32:35]
    ds_read_b64_tr_b16 v[220:221], v16 offset:8200
    v_cvt_pk_bf16_f32 v42, v28, v29
    v_mfma_f32_16x16x32_bf16 v[32:35], v[168:171], a[176:179], v[32:35]
    v_exp_f32 v30, v30
    v_mfma_f32_16x16x32_bf16 v[32:35], v[172:175], a[180:183], v[32:35]
    s_branch L_tail
L_guard:
    s_cmp_eq_u32 s3, 0
    s_cbranch_scc1 L_done
    v_max3_f32 v192, v76, v80, v84
    v_max3_f32 v193, v88, v92, v96
    v_max3_f32 v192, v192, v193, v100
    v_mov_b32 v193, 0
    v_mov_b32 v194, 0
    v_mov_b32 v195, 0
    v_mov_b32 v196, 0
    v_mov_b32 v197, 0
    v_pk_fma_f32 v[192:193], v[104:105], v[194:195], v[192:193]
    v_pk_fma_f32 v[196:197], v[106:107], v[194:195], v[196:197]
    v_pk_fma_f32 v[192:193], v[108:109], v[194:195], v[192:193]
    v_pk_fma_f32 v[196:197], v[110:111], v[194:195], v[196:197]
    v_pk_fma_f32 v[192:193], v[112:113], v[194:195], v[192:193]
    v_pk_fma_f32 v[196:197], v[114:115], v[194:195], v[196:197]
    v_pk_fma_f32 v[192:193], v[116:117], v[194:195], v[192:193]
    v_pk_fma_f32 v[196:197], v[118:119], v[194:195], v[196:197]
    v_pk_fma_f32 v[192:193], v[120:121], v[194:195], v[192:193]
    v_pk_fma_f32 v[196:197], v[122:123], v[194:195], v[196:197]
    v_pk_fma_f32 v[192:193], v[124:125], v[194:195], v[192:193]
    v_pk_fma_f32 v[196:197], v[126:127], v[194:195], v[196:197]
    v_pk_fma_f32 v[192:193], v[128:129], v[194:195], v[192:193]
    v_pk_fma_f32 v[196:197], v[130:131], v[194:195], v[196:197]
    v_pk_fma_f32 v[192:193], v[132:133], v[194:195], v[192:193]
    v_pk_fma_f32 v[196:197], v[134:135], v[194:195], v[196:197]
    v_pk_fma_f32 v[192:193], v[136:137], v[194:195], v[192:193]
    v_pk_fma_f32 v[196:197], v[138:139], v[194:195], v[196:197]
    v_pk_fma_f32 v[192:193], v[140:141], v[194:195], v[192:193]
    v_pk_fma_f32 v[196:197], v[142:143], v[194:195], v[196:197]
    v_pk_fma_f32 v[192:193], v[144:145], v[194:195], v[192:193]
    v_pk_fma_f32 v[196:197], v[146:147], v[194:195], v[196:197]
    v_pk_fma_f32 v[192:193], v[148:149], v[194:195], v[192:193]
    v_pk_fma_f32 v[196:197], v[150:151], v[194:195], v[196:197]
    v_pk_fma_f32 v[192:193], v[152:153], v[194:195], v[192:193]
    v_pk_fma_f32 v[196:197], v[154:155], v[194:195], v[196:197]
    v_pk_fma_f32 v[192:193], v[156:157], v[194:195], v[192:193]
    v_pk_fma_f32 v[196:197], v[158:159], v[194:195], v[196:197]
    v_pk_add_f32 v[192:193], v[192:193], v[196:197]
    v_add_f32 v192, v192, v193
    s_mov_b32 s39, 0x5f800000
    v_cmp_nle_f32 vcc, v192, s39
    s_or_b32 s39, vcc_lo, vcc_hi
    v_mov_b32 v192, s39
    ds_write_b32 v9, v192 offset:38912
    s_waitcnt lgkmcnt(0)
    s_barrier
    ds_read_b128 v[192:195], v10 offset:38912
    s_waitcnt lgkmcnt(0)
    v_or3_b32 v193, v193, v194, v195
    v_or_b32 v192, v192, v193
    s_nop 0
    v_readfirstlane_b32 s39, v192
    s_nop 0
    s_cmp_lg_u32 s39, 0
    s_cbranch_scc1 L_fallback
L_done:
L_end:
    s_endpgm
L_tail:
    ds_read_b64_tr_b16 v[222:223], v16 offset:12296
    v_and_b32 v10, 15, v0
    v_mfma_f32_16x16x32_bf16 v[36:39], v[176:179], a[168:171], v[48:51]
    v_exp_f32 v31, v31
    v_mfma_f32_16x16x32_bf16 v[36:39], v[180:183], a[172:175], v[36:39]
    v_cvt_pk_bf16_f32 v43, v30, v31
    v_lshlrev_b32 v10, 4, v10
    v_mfma_f32_16x16x32_bf16 v[36:39], v[184:187], a[176:179], v[36:39]
    v_lshl_add_u32 v9, s28, 2, v10
    v_mfma_f32_16x16x32_bf16 v[36:39], v[188:191], a[180:183], v[36:39]
    v_exp_f32 v32, v32
    v_mfma_f32_16x16x32_bf16 v[152:155], v[192:195], v[40:43], v[152:155]
    ds_read_b64_tr_b16 v[192:193], v13 offset:8192
    ds_read_b64_tr_b16 v[194:195], v13 offset:12288
    v_mfma_f32_16x16x32_bf16 v[156:159], v[196:199], v[40:43], v[156:159]
    v_exp_f32 v33, v33
    v_mfma_f32_16x16x32_bf16 a[144:147], v[200:203], v[40:43], a[144:147]
    ds_read_b64_tr_b16 v[196:197], v13 offset:8200
    v_cvt_pk_bf16_f32 v44, v32, v33
    v_mfma_f32_16x16x32_bf16 a[148:151], v[204:207], v[40:43], a[148:151]
    v_exp_f32 v34, v34
    v_mfma_f32_16x16x32_bf16 a[152:155], v[208:211], v[40:43], a[152:155]
    ds_read_b64_tr_b16 v[198:199], v13 offset:12296
    ds_read_b64_tr_b16 v[200:201], v14 offset:8192
    v_mfma_f32_16x16x32_bf16 a[156:159], v[212:215], v[40:43], a[156:159]
    v_exp_f32 v35, v35
    v_mfma_f32_16x16x32_bf16 a[160:163], v[248:251], v[40:43], a[160:163]
    ds_read_b64_tr_b16 v[202:203], v14 offset:12288
    v_cvt_pk_bf16_f32 v45, v34, v35
    v_mfma_f32_16x16x32_bf16 a[164:167], v[252:255], v[40:43], a[164:167]
    v_exp_f32 v36, v36
    v_mfma_f32_16x16x32_bf16 v[100:103], v[20:23], v[40:43], v[100:103]
    ds_read_b64_tr_b16 v[204:205], v14 offset:8200
    ds_read_b64_tr_b16 v[206:207], v14 offset:12296
    v_mfma_f32_16x16x32_bf16 v[24:27], v[160:163], a[184:187], v[52:55]
    v_exp_f32 v37, v37
    v_mfma_f32_16x16x32_bf16 v[24:27], v[164:167], a[188:191], v[24:27]
    ds_read_b64_tr_b16 v[208:209], v15 offset:8192
    v_cvt_pk_bf16_f32 v46, v36, v37
    v_mfma_f32_16x16x32_bf16 v[24:27], v[168:171], a[192:195], v[24:27]
    v_exp_f32 v38, v38
    v_mfma_f32_16x16x32_bf16 v[24:27], v[172:175], a[196:199], v[24:27]
    ds_read_b64_tr_b16 v[210:211], v15 offset:12288
    ds_read_b64_tr_b16 v[212:213], v15 offset:8200
    v_mfma_f32_16x16x32_bf16 v[28:31], v[176:179], a[184:187], v[52:55]
    v_exp_f32 v39, v39
    v_mfma_f32_16x16x32_bf16 v[28:31], v[180:183], a[188:191], v[28:31]
    ds_read_b64_tr_b16 v[214:215], v15 offset:12296
    v_cvt_pk_bf16_f32 v47, v38, v39
    v_mfma_f32_16x16x32_bf16 v[28:31], v[184:187], a[192:195], v[28:31]
    s_waitcnt lgkmcnt(6)
    v_mfma_f32_16x16x32_bf16 v[28:31], v[188:191], a[196:199], v[28:31]
    v_exp_f32 v24, v24
    v_mfma_f32_16x16x32_bf16 a[16:19], v[216:219], v[44:47], a[16:19]
    v_mfma_f32_16x16x32_bf16 a[20:23], v[220:223], v[44:47], a[20:23]
    v_exp_f32 v25, v25
    v_mfma_f32_16x16x32_bf16 a[0:3], v[200:203], v[44:47], a[0:3]
    s_waitcnt lgkmcnt(0)
    v_cvt_pk_bf16_f32 v40, v24, v25
    v_mfma_f32_16x16x32_bf16 a[4:7], v[204:207], v[44:47], a[4:7]
    v_exp_f32 v26, v26
    v_mfma_f32_16x16x32_bf16 a[8:11], v[208:211], v[44:47], a[8:11]
    v_mfma_f32_16x16x32_bf16 a[12:15], v[212:215], v[44:47], a[12:15]
    v_exp_f32 v27, v27
    v_mfma_f32_16x16x32_bf16 v[104:107], v[192:195], v[44:47], v[104:107]
    ds_write_b128 v1, a[16:19] offset:4096
    v_cvt_pk_bf16_f32 v41, v26, v27
    v_mfma_f32_16x16x32_bf16 v[108:111], v[196:199], v[44:47], v[108:111]
    v_exp_f32 v28, v28
    v_mfma_f32_16x16x32_bf16 v[76:79], v[20:23], v[44:47], v[76:79]
    ds_write_b128 v1, a[20:23] offset:5120
    v_mfma_f32_16x16x32_bf16 v[32:35], v[160:163], a[200:203], v[56:59]
    v_exp_f32 v29, v29
    v_mfma_f32_16x16x32_bf16 v[32:35], v[164:167], a[204:207], v[32:35]
    v_cvt_pk_bf16_f32 v42, v28, v29
    v_mfma_f32_16x16x32_bf16 v[32:35], v[168:171], a[208:211], v[32:35]
    v_exp_f32 v30, v30
    v_mfma_f32_16x16x32_bf16 v[32:35], v[172:175], a[212:215], v[32:35]
    ds_write_b128 v1, a[0:3] offset:0
    v_mfma_f32_16x16x32_bf16 v[36:39], v[176:179], a[200:203], v[56:59]
    v_exp_f32 v31, v31
    v_mfma_f32_16x16x32_bf16 v[36:39], v[180:183], a[204:207], v[36:39]
    ds_write_b32 v9, v76 offset:36864
    v_cvt_pk_bf16_f32 v43, v30, v31
    v_mfma_f32_16x16x32_bf16 v[36:39], v[184:187], a[208:211], v[36:39]
    ds_write_b128 v1, a[4:7] offset:1024
    v_mfma_f32_16x16x32_bf16 v[36:39], v[188:191], a[212:215], v[36:39]
    v_exp_f32 v32, v32
    v_mfma_f32_16x16x32_bf16 a[40:43], v[216:219], v[40:43], a[40:43]
    ds_write_b128 v1, a[8:11] offset:2048
    v_mfma_f32_16x16x32_bf16 a[44:47], v[220:223], v[40:43], a[44:47]
    v_exp_f32 v33, v33
    v_mfma_f32_16x16x32_bf16 a[24:27], v[200:203], v[40:43], a[24:27]
    v_cvt_pk_bf16_f32 v44, v32, v33
    v_mfma_f32_16x16x32_bf16 a[28:31], v[204:207], v[40:43], a[28:31]
    v_exp_f32 v34, v34
    v_mfma_f32_16x16x32_bf16 a[32:35], v[208:211], v[40:43], a[32:35]
    ds_write_b128 v1, a[12:15] offset:3072
    v_mfma_f32_16x16x32_bf16 a[36:39], v[212:215], v[40:43], a[36:39]
    v_exp_f32 v35, v35
    v_mfma_f32_16x16x32_bf16 v[112:115], v[192:195], v[40:43], v[112:115]
    ds_write_b128 v1, a[40:43] offset:10240
    v_cvt_pk_bf16_f32 v45, v34, v35
    v_mfma_f32_16x16x32_bf16 v[116:119], v[196:199], v[40:43], v[116:119]
    v_exp_f32 v36, v36
    v_mfma_f32_16x16x32_bf16 v[80:83], v[20:23], v[40:43], v[80:83]
    ds_write_b128 v1, a[44:47] offset:11264
    v_mfma_f32_16x16x32_bf16 v[24:27], v[160:163], a[216:219], v[60:63]
    v_exp_f32 v37, v37
    v_mfma_f32_16x16x32_bf16 v[24:27], v[164:167], a[220:223], v[24:27]
    s_waitcnt lgkmcnt(2)
    s_barrier
    ds_read_b128 v[76:79], v10 offset:36864
    v_cvt_pk_bf16_f32 v46, v36, v37
    v_mfma_f32_16x16x32_bf16 v[24:27], v[168:171], a[224:227], v[24:27]
    ds_read_b128 v[48:51], v17 offset:0
    v_exp_f32 v38, v38
    v_mfma_f32_16x16x32_bf16 v[24:27], v[172:175], a[228:231], v[24:27]
    ds_write_b128 v1, a[24:27] offset:6144
    v_mfma_f32_16x16x32_bf16 v[28:31], v[176:179], a[216:219], v[60:63]
    ds_read_b128 v[52:55], v17 offset:1024
    v_exp_f32 v39, v39
    v_mfma_f32_16x16x32_bf16 v[28:31], v[180:183], a[220:223], v[28:31]
    ds_read_b128 v[56:59], v18 offset:2048
    ds_write_b32 v9, v80 offset:37120
    v_cvt_pk_bf16_f32 v47, v38, v39
    v_mfma_f32_16x16x32_bf16 v[28:31], v[184:187], a[224:227], v[28:31]
    ds_write_b128 v1, a[28:31] offset:7168
    v_mfma_f32_16x16x32_bf16 v[28:31], v[188:191], a[228:231], v[28:31]
    ds_read_b128 v[248:251], v18 offset:3072
    v_exp_f32 v24, v24
    v_mfma_f32_16x16x32_bf16 a[64:67], v[216:219], v[44:47], a[64:67]
    ds_write_b128 v1, a[32:35] offset:8192
    v_mfma_f32_16x16x32_bf16 a[68:71], v[220:223], v[44:47], a[68:71]
    ds_read_b128 v[252:255], v19 offset:4096
    v_exp_f32 v25, v25
    v_mfma_f32_16x16x32_bf16 a[48:51], v[200:203], v[44:47], a[48:51]
    ds_read_b128 v[4:7], v19 offset:5120
    v_cvt_pk_bf16_f32 v40, v24, v25
    v_mfma_f32_16x16x32_bf16 a[52:55], v[204:207], v[44:47], a[52:55]
    v_exp_f32 v26, v26
    v_mfma_f32_16x16x32_bf16 a[56:59], v[208:211], v[44:47], a[56:59]
    ds_write_b128 v1, a[36:39] offset:9216
    v_mfma_f32_16x16x32_bf16 a[60:63], v[212:215], v[44:47], a[60:63]
    v_exp_f32 v27, v27
    v_mfma_f32_16x16x32_bf16 v[120:123], v[192:195], v[44:47], v[120:123]
    ds_write_b128 v1, a[64:67] offset:16384
    v_cvt_pk_bf16_f32 v41, v26, v27
    v_mfma_f32_16x16x32_bf16 v[124:127], v[196:199], v[44:47], v[124:127]
    s_waitcnt lgkmcnt(2)
    v_exp_f32 v28, v28
    v_add_f32 v77, v77, v78
    v_add_f32 v76, v76, v79
    v_add_f32 v76, v76, v77
    v_rcp_f32 v78, v76
    v_pk_add_f32 v[104:105], v[104:105], v[48:49]
    v_pk_add_f32 v[56:57], v[56:57], v[252:253]
    v_pk_add_f32 v[106:107], v[106:107], v[50:51]
    v_pk_add_f32 v[58:59], v[58:59], v[254:255]
    v_pk_add_f32 v[108:109], v[108:109], v[52:53]
    v_pk_add_f32 v[248:249], v[248:249], v[4:5]
    v_pk_add_f32 v[110:111], v[110:111], v[54:55]
    v_pk_add_f32 v[250:251], v[250:251], v[6:7]
    v_pk_add_f32 v[104:105], v[104:105], v[56:57]
    v_pk_add_f32 v[106:107], v[106:107], v[58:59]
    v_pk_add_f32 v[108:109], v[108:109], v[248:249]
    v_pk_add_f32 v[110:111], v[110:111], v[250:251]
    v_pk_mul_f32 v[104:105], v[104:105], v[78:79] op_sel_hi:[1,0]
    v_pk_mul_f32 v[106:107], v[106:107], v[78:79] op_sel_hi:[1,0]
    v_pk_mul_f32 v[108:109], v[108:109], v[78:79] op_sel_hi:[1,0]
    v_pk_mul_f32 v[110:111], v[110:111], v[78:79] op_sel_hi:[1,0]
    v_cvt_pk_bf16_f32 v48, v104, v105
    v_cvt_pk_bf16_f32 v49, v106, v107
    v_cvt_pk_bf16_f32 v50, v108, v109
    v_cvt_pk_bf16_f32 v51, v110, v111
    v_mfma_f32_16x16x32_bf16 v[84:87], v[20:23], v[44:47], v[84:87]
    buffer_store_dwordx4 v[48:51], v2, s[24:27], s48 offen sc1
    ds_write_b128 v1, a[68:71] offset:17408
    v_mfma_f32_16x16x32_bf16 v[32:35], v[160:163], a[232:235], v[64:67]
    v_exp_f32 v29, v29
    v_mfma_f32_16x16x32_bf16 v[32:35], v[164:167], a[236:239], v[32:35]
    s_waitcnt lgkmcnt(2)
    s_barrier
    ds_read_b128 v[80:83], v10 offset:37120
    v_cvt_pk_bf16_f32 v42, v28, v29
    v_mfma_f32_16x16x32_bf16 v[32:35], v[168:171], a[240:243], v[32:35]
    ds_read_b128 v[48:51], v17 offset:6144
    v_exp_f32 v30, v30
    v_mfma_f32_16x16x32_bf16 v[32:35], v[172:175], a[244:247], v[32:35]
    ds_write_b128 v1, a[48:51] offset:12288
    v_mfma_f32_16x16x32_bf16 v[36:39], v[176:179], a[232:235], v[64:67]
    ds_read_b128 v[52:55], v17 offset:7168
    v_exp_f32 v31, v31
    v_mfma_f32_16x16x32_bf16 v[36:39], v[180:183], a[236:239], v[36:39]
    ds_read_b128 v[56:59], v18 offset:8192
    ds_write_b32 v9, v84 offset:37376
    v_cvt_pk_bf16_f32 v43, v30, v31
    v_mfma_f32_16x16x32_bf16 v[36:39], v[184:187], a[240:243], v[36:39]
    ds_write_b128 v1, a[52:55] offset:13312
    v_mfma_f32_16x16x32_bf16 v[36:39], v[188:191], a[244:247], v[36:39]
    ds_read_b128 v[248:251], v18 offset:9216
    v_exp_f32 v32, v32
    v_mfma_f32_16x16x32_bf16 a[88:91], v[216:219], v[40:43], a[88:91]
    ds_write_b128 v1, a[56:59] offset:14336
    v_mfma_f32_16x16x32_bf16 a[92:95], v[220:223], v[40:43], a[92:95]
    ds_read_b128 v[252:255], v19 offset:10240
    v_exp_f32 v33, v33
    v_mfma_f32_16x16x32_bf16 a[72:75], v[200:203], v[40:43], a[72:75]
    ds_read_b128 v[4:7], v19 offset:11264
    v_cvt_pk_bf16_f32 v44, v32, v33
    v_mfma_f32_16x16x32_bf16 a[76:79], v[204:207], v[40:43], a[76:79]
    v_exp_f32 v34, v34
    v_mfma_f32_16x16x32_bf16 a[80:83], v[208:211], v[40:43], a[80:83]
    ds_write_b128 v1, a[60:63] offset:15360
    v_mfma_f32_16x16x32_bf16 a[84:87], v[212:215], v[40:43], a[84:87]
    v_exp_f32 v35, v35
    v_mfma_f32_16x16x32_bf16 v[128:131], v[192:195], v[40:43], v[128:131]
    ds_write_b128 v1, a[88:91] offset:22528
    v_cvt_pk_bf16_f32 v45, v34, v35
    v_mfma_f32_16x16x32_bf16 v[132:135], v[196:199], v[40:43], v[132:135]
    s_waitcnt lgkmcnt(2)
    v_exp_f32 v36, v36
    v_add_f32 v81, v81, v82
    v_add_f32 v80, v80, v83
    v_add_f32 v80, v80, v81
    v_rcp_f32 v82, v80
    v_pk_add_f32 v[112:113], v[112:113], v[48:49]
    v_pk_add_f32 v[56:57], v[56:57], v[252:253]
    v_pk_add_f32 v[114:115], v[114:115], v[50:51]
    v_pk_add_f32 v[58:59], v[58:59], v[254:255]
    v_pk_add_f32 v[116:117], v[116:117], v[52:53]
    v_pk_add_f32 v[248:249], v[248:249], v[4:5]
    v_pk_add_f32 v[118:119], v[118:119], v[54:55]
    v_pk_add_f32 v[250:251], v[250:251], v[6:7]
    v_pk_add_f32 v[112:113], v[112:113], v[56:57]
    v_pk_add_f32 v[114:115], v[114:115], v[58:59]
    v_pk_add_f32 v[116:117], v[116:117], v[248:249]
    v_pk_add_f32 v[118:119], v[118:119], v[250:251]
    v_pk_mul_f32 v[112:113], v[112:113], v[82:83] op_sel_hi:[1,0]
    v_pk_mul_f32 v[114:115], v[114:115], v[82:83] op_sel_hi:[1,0]
    v_pk_mul_f32 v[116:117], v[116:117], v[82:83] op_sel_hi:[1,0]
    v_pk_mul_f32 v[118:119], v[118:119], v[82:83] op_sel_hi:[1,0]
    v_cvt_pk_bf16_f32 v48, v112, v113
    v_cvt_pk_bf16_f32 v49, v114, v115
    v_cvt_pk_bf16_f32 v50, v116, v117
    v_cvt_pk_bf16_f32 v51, v118, v119
    v_mfma_f32_16x16x32_bf16 v[88:91], v[20:23], v[40:43], v[88:91]
    buffer_store_dwordx4 v[48:51], v2, s[24:27], s49 offen sc1
    ds_write_b128 v1, a[92:95] offset:23552
    v_mfma_f32_16x16x32_bf16 v[24:27], v[160:163], a[248:251], v[68:71]
    v_exp_f32 v37, v37
    v_mfma_f32_16x16x32_bf16 v[24:27], v[164:167], a[252:255], v[24:27]
    s_waitcnt lgkmcnt(2)
    s_barrier
    ds_read_b128 v[84:87], v10 offset:37376
    v_cvt_pk_bf16_f32 v46, v36, v37
    v_mfma_f32_16x16x32_bf16 v[24:27], v[168:171], v[224:227], v[24:27]
    ds_read_b128 v[48:51], v17 offset:12288
    v_exp_f32 v38, v38
    v_mfma_f32_16x16x32_bf16 v[24:27], v[172:175], v[228:231], v[24:27]
    ds_write_b128 v1, a[72:75] offset:18432
    v_mfma_f32_16x16x32_bf16 v[28:31], v[176:179], a[248:251], v[68:71]
    ds_read_b128 v[52:55], v17 offset:13312
    v_exp_f32 v39, v39
    v_mfma_f32_16x16x32_bf16 v[28:31], v[180:183], a[252:255], v[28:31]
    ds_read_b128 v[56:59], v18 offset:14336
    ds_write_b32 v9, v88 offset:37632
    v_cvt_pk_bf16_f32 v47, v38, v39
    v_mfma_f32_16x16x32_bf16 v[28:31], v[184:187], v[224:227], v[28:31]
    ds_write_b128 v1, a[76:79] offset:19456
    v_mfma_f32_16x16x32_bf16 v[28:31], v[188:191], v[228:231], v[28:31]
    ds_read_b128 v[248:251], v18 offset:15360
    v_exp_f32 v24, v24
    v_mfma_f32_16x16x32_bf16 a[112:115], v[216:219], v[44:47], a[112:115]
    ds_write_b128 v1, a[80:83] offset:20480
    v_mfma_f32_16x16x32_bf16 a[116:119], v[220:223], v[44:47], a[116:119]
    ds_read_b128 v[252:255], v19 offset:16384
    v_exp_f32 v25, v25
    v_mfma_f32_16x16x32_bf16 a[96:99], v[200:203], v[44:47], a[96:99]
    ds_read_b128 v[4:7], v19 offset:17408
    v_cvt_pk_bf16_f32 v40, v24, v25
    v_mfma_f32_16x16x32_bf16 a[100:103], v[204:207], v[44:47], a[100:103]
    v_exp_f32 v26, v26
    v_mfma_f32_16x16x32_bf16 a[104:107], v[208:211], v[44:47], a[104:107]
    ds_write_b128 v1, a[84:87] offset:21504
    v_mfma_f32_16x16x32_bf16 a[108:111], v[212:215], v[44:47], a[108:111]
    v_exp_f32 v27, v27
    v_mfma_f32_16x16x32_bf16 v[136:139], v[192:195], v[44:47], v[136:139]
    ds_write_b128 v1, a[112:115] offset:28672
    v_cvt_pk_bf16_f32 v41, v26, v27
    v_mfma_f32_16x16x32_bf16 v[140:143], v[196:199], v[44:47], v[140:143]
    s_waitcnt lgkmcnt(2)
    v_exp_f32 v28, v28
    v_add_f32 v85, v85, v86
    v_add_f32 v84, v84, v87
    v_add_f32 v84, v84, v85
    v_rcp_f32 v86, v84
    v_pk_add_f32 v[120:121], v[120:121], v[48:49]
    v_pk_add_f32 v[56:57], v[56:57], v[252:253]
    v_pk_add_f32 v[122:123], v[122:123], v[50:51]
    v_pk_add_f32 v[58:59], v[58:59], v[254:255]
    v_pk_add_f32 v[124:125], v[124:125], v[52:53]
    v_pk_add_f32 v[248:249], v[248:249], v[4:5]
    v_pk_add_f32 v[126:127], v[126:127], v[54:55]
    v_pk_add_f32 v[250:251], v[250:251], v[6:7]
    v_pk_add_f32 v[120:121], v[120:121], v[56:57]
    v_pk_add_f32 v[122:123], v[122:123], v[58:59]
    v_pk_add_f32 v[124:125], v[124:125], v[248:249]
    v_pk_add_f32 v[126:127], v[126:127], v[250:251]
    v_pk_mul_f32 v[120:121], v[120:121], v[86:87] op_sel_hi:[1,0]
    v_pk_mul_f32 v[122:123], v[122:123], v[86:87] op_sel_hi:[1,0]
    v_pk_mul_f32 v[124:125], v[124:125], v[86:87] op_sel_hi:[1,0]
    v_pk_mul_f32 v[126:127], v[126:127], v[86:87] op_sel_hi:[1,0]
    v_cvt_pk_bf16_f32 v48, v120, v121
    v_cvt_pk_bf16_f32 v49, v122, v123
    v_cvt_pk_bf16_f32 v50, v124, v125
    v_cvt_pk_bf16_f32 v51, v126, v127
    v_mfma_f32_16x16x32_bf16 v[92:95], v[20:23], v[44:47], v[92:95]
    buffer_store_dwordx4 v[48:51], v2, s[24:27], s50 offen sc1
    ds_write_b128 v1, a[116:119] offset:29696
    v_mfma_f32_16x16x32_bf16 v[32:35], v[160:163], v[232:235], v[72:75]
    v_exp_f32 v29, v29
    v_mfma_f32_16x16x32_bf16 v[32:35], v[164:167], v[236:239], v[32:35]
    s_waitcnt lgkmcnt(2)
    s_barrier
    ds_read_b128 v[88:91], v10 offset:37632
    v_cvt_pk_bf16_f32 v42, v28, v29
    v_mfma_f32_16x16x32_bf16 v[32:35], v[168:171], v[240:243], v[32:35]
    ds_read_b128 v[48:51], v17 offset:18432
    v_exp_f32 v30, v30
    v_mfma_f32_16x16x32_bf16 v[32:35], v[172:175], v[244:247], v[32:35]
    ds_write_b128 v1, a[96:99] offset:24576
    v_mfma_f32_16x16x32_bf16 v[36:39], v[176:179], v[232:235], v[72:75]
    ds_read_b128 v[52:55], v17 offset:19456
    v_exp_f32 v31, v31
    v_mfma_f32_16x16x32_bf16 v[36:39], v[180:183], v[236:239], v[36:39]
    ds_read_b128 v[56:59], v18 offset:20480
    ds_write_b32 v9, v92 offset:37888
    v_cvt_pk_bf16_f32 v43, v30, v31
    v_mfma_f32_16x16x32_bf16 v[36:39], v[184:187], v[240:243], v[36:39]
    ds_write_b128 v1, a[100:103] offset:25600
    v_mfma_f32_16x16x32_bf16 v[36:39], v[188:191], v[244:247], v[36:39]
    ds_read_b128 v[248:251], v18 offset:21504
    v_exp_f32 v32, v32
    v_mfma_f32_16x16x32_bf16 a[136:139], v[216:219], v[40:43], a[136:139]
    ds_write_b128 v1, a[104:107] offset:26624
    v_mfma_f32_16x16x32_bf16 a[140:143], v[220:223], v[40:43], a[140:143]
    ds_read_b128 v[252:255], v19 offset:22528
    v_exp_f32 v33, v33
    v_mfma_f32_16x16x32_bf16 a[120:123], v[200:203], v[40:43], a[120:123]
    ds_read_b128 v[4:7], v19 offset:23552
    v_cvt_pk_bf16_f32 v44, v32, v33
    v_mfma_f32_16x16x32_bf16 a[124:127], v[204:207], v[40:43], a[124:127]
    v_exp_f32 v34, v34
    v_mfma_f32_16x16x32_bf16 a[128:131], v[208:211], v[40:43], a[128:131]
    ds_write_b128 v1, a[108:111] offset:27648
    v_mfma_f32_16x16x32_bf16 a[132:135], v[212:215], v[40:43], a[132:135]
    v_exp_f32 v35, v35
    v_mfma_f32_16x16x32_bf16 v[144:147], v[192:195], v[40:43], v[144:147]
    ds_write_b128 v1, a[136:139] offset:34816
    v_cvt_pk_bf16_f32 v45, v34, v35
    v_mfma_f32_16x16x32_bf16 v[148:151], v[196:199], v[40:43], v[148:151]
    s_waitcnt lgkmcnt(2)
    v_exp_f32 v36, v36
    v_add_f32 v89, v89, v90
    v_add_f32 v88, v88, v91
    v_add_f32 v88, v88, v89
    v_rcp_f32 v90, v88
    v_pk_add_f32 v[128:129], v[128:129], v[48:49]
    v_pk_add_f32 v[56:57], v[56:57], v[252:253]
    v_pk_add_f32 v[130:131], v[130:131], v[50:51]
    v_pk_add_f32 v[58:59], v[58:59], v[254:255]
    v_pk_add_f32 v[132:133], v[132:133], v[52:53]
    v_pk_add_f32 v[248:249], v[248:249], v[4:5]
    v_pk_add_f32 v[134:135], v[134:135], v[54:55]
    v_pk_add_f32 v[250:251], v[250:251], v[6:7]
    v_pk_add_f32 v[128:129], v[128:129], v[56:57]
    v_pk_add_f32 v[130:131], v[130:131], v[58:59]
    v_pk_add_f32 v[132:133], v[132:133], v[248:249]
    v_pk_add_f32 v[134:135], v[134:135], v[250:251]
    v_pk_mul_f32 v[128:129], v[128:129], v[90:91] op_sel_hi:[1,0]
    v_pk_mul_f32 v[130:131], v[130:131], v[90:91] op_sel_hi:[1,0]
    v_pk_mul_f32 v[132:133], v[132:133], v[90:91] op_sel_hi:[1,0]
    v_pk_mul_f32 v[134:135], v[134:135], v[90:91] op_sel_hi:[1,0]
    v_cvt_pk_bf16_f32 v48, v128, v129
    v_cvt_pk_bf16_f32 v49, v130, v131
    v_cvt_pk_bf16_f32 v50, v132, v133
    v_cvt_pk_bf16_f32 v51, v134, v135
    v_mfma_f32_16x16x32_bf16 v[96:99], v[20:23], v[40:43], v[96:99]
    buffer_store_dwordx4 v[48:51], v2, s[24:27], s51 offen sc1
    ds_write_b128 v1, a[140:143] offset:35840
    v_exp_f32 v37, v37
    s_waitcnt lgkmcnt(2)
    s_barrier
    ds_read_b128 v[92:95], v10 offset:37888
    ds_write_b128 v1, a[120:123] offset:30720
    v_cvt_pk_bf16_f32 v46, v36, v37
    ds_read_b128 v[48:51], v17 offset:24576
    v_exp_f32 v38, v38
    ds_write_b128 v1, a[124:127] offset:31744
    ds_read_b128 v[52:55], v17 offset:25600
    v_exp_f32 v39, v39
    ds_read_b128 v[56:59], v18 offset:26624
    ds_write_b32 v9, v96 offset:38144
    v_cvt_pk_bf16_f32 v47, v38, v39
    ds_write_b128 v1, a[128:131] offset:32768
    s_nop 0
    v_mfma_f32_16x16x32_bf16 v[100:103], v[20:23], v[44:47], v[100:103]
    ds_read_b128 v[248:251], v18 offset:27648
    v_mfma_f32_16x16x32_bf16 a[160:163], v[216:219], v[44:47], a[160:163]
    ds_write_b128 v1, a[132:135] offset:33792
    v_mfma_f32_16x16x32_bf16 a[164:167], v[220:223], v[44:47], a[164:167]
    ds_read_b128 v[252:255], v19 offset:28672
    v_mfma_f32_16x16x32_bf16 a[144:147], v[200:203], v[44:47], a[144:147]
    ds_read_b128 v[4:7], v19 offset:29696
    v_mfma_f32_16x16x32_bf16 a[148:151], v[204:207], v[44:47], a[148:151]
    v_mfma_f32_16x16x32_bf16 a[152:155], v[208:211], v[44:47], a[152:155]
    s_waitcnt lgkmcnt(2)
    s_barrier
    ds_read_b128 v[96:99], v10 offset:38144
    ds_read_b128 v[160:163], v17 offset:30720
    ds_read_b128 v[164:167], v17 offset:31744
    ds_read_b128 v[168:171], v18 offset:32768
    ds_read_b128 v[172:175], v18 offset:33792
    ds_read_b128 v[176:179], v19 offset:34816
    ds_read_b128 v[180:183], v19 offset:35840
    v_mfma_f32_16x16x32_bf16 a[156:159], v[212:215], v[44:47], a[156:159]
    v_mfma_f32_16x16x32_bf16 v[152:155], v[192:195], v[44:47], v[152:155]
    v_mfma_f32_16x16x32_bf16 v[156:159], v[196:199], v[44:47], v[156:159]
    s_waitcnt lgkmcnt(7)
    v_add_f32 v93, v93, v94
    v_add_f32 v92, v92, v95
    v_add_f32 v92, v92, v93
    v_rcp_f32 v94, v92
    v_pk_add_f32 v[136:137], v[136:137], v[48:49]
    v_pk_add_f32 v[56:57], v[56:57], v[252:253]
    v_pk_add_f32 v[138:139], v[138:139], v[50:51]
    v_pk_add_f32 v[58:59], v[58:59], v[254:255]
    v_pk_add_f32 v[140:141], v[140:141], v[52:53]
    v_pk_add_f32 v[248:249], v[248:249], v[4:5]
    v_pk_add_f32 v[142:143], v[142:143], v[54:55]
    v_pk_add_f32 v[250:251], v[250:251], v[6:7]
    v_pk_add_f32 v[136:137], v[136:137], v[56:57]
    v_pk_add_f32 v[138:139], v[138:139], v[58:59]
    v_pk_add_f32 v[140:141], v[140:141], v[248:249]
    v_pk_add_f32 v[142:143], v[142:143], v[250:251]
    v_pk_mul_f32 v[136:137], v[136:137], v[94:95] op_sel_hi:[1,0]
    v_pk_mul_f32 v[138:139], v[138:139], v[94:95] op_sel_hi:[1,0]
    v_pk_mul_f32 v[140:141], v[140:141], v[94:95] op_sel_hi:[1,0]
    v_pk_mul_f32 v[142:143], v[142:143], v[94:95] op_sel_hi:[1,0]
    v_cvt_pk_bf16_f32 v48, v136, v137
    v_cvt_pk_bf16_f32 v49, v138, v139
    v_cvt_pk_bf16_f32 v50, v140, v141
    v_cvt_pk_bf16_f32 v51, v142, v143
    buffer_store_dwordx4 v[48:51], v2, s[24:27], s52 offen sc1
    ds_write_b32 v9, v100 offset:38400
    ds_write_b128 v1, a[160:163] offset:4096
    ds_write_b128 v1, a[164:167] offset:5120
    s_waitcnt lgkmcnt(3)
    v_add_f32 v97, v97, v98
    v_add_f32 v96, v96, v99
    v_add_f32 v96, v96, v97
    v_rcp_f32 v98, v96
    v_pk_add_f32 v[144:145], v[144:145], v[160:161]
    v_pk_add_f32 v[168:169], v[168:169], v[176:177]
    v_pk_add_f32 v[146:147], v[146:147], v[162:163]
    v_pk_add_f32 v[170:171], v[170:171], v[178:179]
    v_pk_add_f32 v[148:149], v[148:149], v[164:165]
    v_pk_add_f32 v[172:173], v[172:173], v[180:181]
    v_pk_add_f32 v[150:151], v[150:151], v[166:167]
    v_pk_add_f32 v[174:175], v[174:175], v[182:183]
    ds_write_b128 v1, a[144:147] offset:0
    ds_write_b128 v1, a[148:151] offset:1024
    v_pk_add_f32 v[144:145], v[144:145], v[168:169]
    v_pk_add_f32 v[146:147], v[146:147], v[170:171]
    v_pk_add_f32 v[148:149], v[148:149], v[172:173]
    v_pk_add_f32 v[150:151], v[150:151], v[174:175]
    v_pk_mul_f32 v[144:145], v[144:145], v[98:99] op_sel_hi:[1,0]
    v_pk_mul_f32 v[146:147], v[146:147], v[98:99] op_sel_hi:[1,0]
    v_pk_mul_f32 v[148:149], v[148:149], v[98:99] op_sel_hi:[1,0]
    v_pk_mul_f32 v[150:151], v[150:151], v[98:99] op_sel_hi:[1,0]
    v_cvt_pk_bf16_f32 v160, v144, v145
    v_cvt_pk_bf16_f32 v161, v146, v147
    v_cvt_pk_bf16_f32 v162, v148, v149
    v_cvt_pk_bf16_f32 v163, v150, v151
    buffer_store_dwordx4 v[160:163], v2, s[24:27], s53 offen sc1
    ds_write_b128 v1, a[152:155] offset:2048
    ds_write_b128 v1, a[156:159] offset:3072
    s_waitcnt lgkmcnt(0)
    s_barrier
    ds_read_b128 v[100:103], v10 offset:38400
    ds_read_b128 v[184:187], v17 offset:0
    ds_read_b128 v[188:191], v17 offset:1024
    ds_read_b128 v[60:63], v18 offset:2048
    ds_read_b128 v[64:67], v18 offset:3072
    ds_read_b128 v[68:71], v19 offset:4096
    ds_read_b128 v[72:75], v19 offset:5120
    s_waitcnt lgkmcnt(6)
    v_add_f32 v101, v101, v102
    v_add_f32 v100, v100, v103
    v_add_f32 v100, v100, v101
    v_rcp_f32 v102, v100
    s_waitcnt lgkmcnt(0)
    v_pk_add_f32 v[152:153], v[152:153], v[184:185]
    v_pk_add_f32 v[60:61], v[60:61], v[68:69]
    v_pk_add_f32 v[154:155], v[154:155], v[186:187]
    v_pk_add_f32 v[62:63], v[62:63], v[70:71]
    v_pk_add_f32 v[156:157], v[156:157], v[188:189]
    v_pk_add_f32 v[64:65], v[64:65], v[72:73]
    v_pk_add_f32 v[158:159], v[158:159], v[190:191]
    v_pk_add_f32 v[66:67], v[66:67], v[74:75]
    v_pk_add_f32 v[152:153], v[152:153], v[60:61]
    v_pk_add_f32 v[154:155], v[154:155], v[62:63]
    v_pk_add_f32 v[156:157], v[156:157], v[64:65]
    v_pk_add_f32 v[158:159], v[158:159], v[66:67]
    v_pk_mul_f32 v[152:153], v[152:153], v[102:103] op_sel_hi:[1,0]
    v_pk_mul_f32 v[154:155], v[154:155], v[102:103] op_sel_hi:[1,0]
    v_pk_mul_f32 v[156:157], v[156:157], v[102:103] op_sel_hi:[1,0]
    v_pk_mul_f32 v[158:159], v[158:159], v[102:103] op_sel_hi:[1,0]
    v_cvt_pk_bf16_f32 v184, v152, v153
    v_cvt_pk_bf16_f32 v185, v154, v155
    v_cvt_pk_bf16_f32 v186, v156, v157
    v_cvt_pk_bf16_f32 v187, v158, v159
    buffer_store_dwordx4 v[184:187], v2, s[24:27], s54 offen sc1
    s_branch L_guard
L_fallback:
    s_waitcnt vmcnt(0)
    s_barrier
    v_and_b32 v2, 15, v0
    v_lshlrev_b32 v3, 8, v2
    v_and_b32 v17, 48, v0
    v_add_u32 v3, v3, v17
    s_lshl_b32 s39, s28, 16
    s_mov_b32 s38, 8
    v_mov_b32 v248, 0xff800000
    v_mov_b32 v249, 0xff800000
    v_mov_b32 v250, 0xff800000
    v_mov_b32 v251, 0xff800000
    v_mov_b32 v252, 0xff800000
    v_mov_b32 v253, 0xff800000
    v_mov_b32 v254, 0xff800000
    v_mov_b32 v255, 0xff800000
L_mx:
    s_add_u32 s29, s39, 4096
    buffer_load_dwordx4 v[160:163], v3, s[16:19], s39 offen offset:0
    buffer_load_dwordx4 v[164:167], v3, s[16:19], s39 offen offset:64
    buffer_load_dwordx4 v[168:171], v3, s[16:19], s39 offen offset:128
    buffer_load_dwordx4 v[172:175], v3, s[16:19], s39 offen offset:192
    buffer_load_dwordx4 v[176:179], v3, s[16:19], s29 offen offset:0
    buffer_load_dwordx4 v[180:183], v3, s[16:19], s29 offen offset:64
    buffer_load_dwordx4 v[184:187], v3, s[16:19], s29 offen offset:128
    buffer_load_dwordx4 v[188:191], v3, s[16:19], s29 offen offset:192
    s_waitcnt vmcnt(0)
    v_mfma_f32_16x16x32_bf16 v[24:27], v[160:163], a[168:171], 0
    v_mfma_f32_16x16x32_bf16 v[24:27], v[164:167], a[172:175], v[24:27]
    v_mfma_f32_16x16x32_bf16 v[24:27], v[168:171], a[176:179], v[24:27]
    v_mfma_f32_16x16x32_bf16 v[24:27], v[172:175], a[180:183], v[24:27]
    v_mfma_f32_16x16x32_bf16 v[28:31], v[176:179], a[168:171], 0
    v_mfma_f32_16x16x32_bf16 v[28:31], v[180:183], a[172:175], v[28:31]
    v_mfma_f32_16x16x32_bf16 v[28:31], v[184:187], a[176:179], v[28:31]
    v_mfma_f32_16x16x32_bf16 v[28:31], v[188:191], a[180:183], v[28:31]
    s_nop 3
    v_max3_f32 v248, v248, v24, v25
    v_max3_f32 v248, v248, v26, v27
    s_nop 1
    v_max3_f32 v248, v248, v28, v29
    v_max3_f32 v248, v248, v30, v31
    v_mfma_f32_16x16x32_bf16 v[32:35], v[160:163], a[184:187], 0
    v_mfma_f32_16x16x32_bf16 v[32:35], v[164:167], a[188:191], v[32:35]
    v_mfma_f32_16x16x32_bf16 v[32:35], v[168:171], a[192:195], v[32:35]
    v_mfma_f32_16x16x32_bf16 v[32:35], v[172:175], a[196:199], v[32:35]
    v_mfma_f32_16x16x32_bf16 v[36:39], v[176:179], a[184:187], 0
    v_mfma_f32_16x16x32_bf16 v[36:39], v[180:183], a[188:191], v[36:39]
    v_mfma_f32_16x16x32_bf16 v[36:39], v[184:187], a[192:195], v[36:39]
    v_mfma_f32_16x16x32_bf16 v[36:39], v[188:191], a[196:199], v[36:39]
    s_nop 3
    v_max3_f32 v249, v249, v32, v33
    v_max3_f32 v249, v249, v34, v35
    s_nop 1
    v_max3_f32 v249, v249, v36, v37
    v_max3_f32 v249, v249, v38, v39
    v_mfma_f32_16x16x32_bf16 v[24:27], v[160:163], a[200:203], 0
    v_mfma_f32_16x16x32_bf16 v[24:27], v[164:167], a[204:207], v[24:27]
    v_mfma_f32_16x16x32_bf16 v[24:27], v[168:171], a[208:211], v[24:27]
    v_mfma_f32_16x16x32_bf16 v[24:27], v[172:175], a[212:215], v[24:27]
    v_mfma_f32_16x16x32_bf16 v[28:31], v[176:179], a[200:203], 0
    v_mfma_f32_16x16x32_bf16 v[28:31], v[180:183], a[204:207], v[28:31]
    v_mfma_f32_16x16x32_bf16 v[28:31], v[184:187], a[208:211], v[28:31]
    v_mfma_f32_16x16x32_bf16 v[28:31], v[188:191], a[212:215], v[28:31]
    s_nop 3
    v_max3_f32 v250, v250, v24, v25
    v_max3_f32 v250, v250, v26, v27
    s_nop 1
    v_max3_f32 v250, v250, v28, v29
    v_max3_f32 v250, v250, v30, v31
    v_mfma_f32_16x16x32_bf16 v[32:35], v[160:163], a[216:219], 0
    v_mfma_f32_16x16x32_bf16 v[32:35], v[164:167], a[220:223], v[32:35]
    v_mfma_f32_16x16x32_bf16 v[32:35], v[168:171], a[224:227], v[32:35]
    v_mfma_f32_16x16x32_bf16 v[32:35], v[172:175], a[228:231], v[32:35]
    v_mfma_f32_16x16x32_bf16 v[36:39], v[176:179], a[216:219], 0
    v_mfma_f32_16x16x32_bf16 v[36:39], v[180:183], a[220:223], v[36:39]
    v_mfma_f32_16x16x32_bf16 v[36:39], v[184:187], a[224:227], v[36:39]
    v_mfma_f32_16x16x32_bf16 v[36:39], v[188:191], a[228:231], v[36:39]
    s_nop 3
    v_max3_f32 v251, v251, v32, v33
    v_max3_f32 v251, v251, v34, v35
    s_nop 1
    v_max3_f32 v251, v251, v36, v37
    v_max3_f32 v251, v251, v38, v39
    v_mfma_f32_16x16x32_bf16 v[24:27], v[160:163], a[232:235], 0
    v_mfma_f32_16x16x32_bf16 v[24:27], v[164:167], a[236:239], v[24:27]
    v_mfma_f32_16x16x32_bf16 v[24:27], v[168:171], a[240:243], v[24:27]
    v_mfma_f32_16x16x32_bf16 v[24:27], v[172:175], a[244:247], v[24:27]
    v_mfma_f32_16x16x32_bf16 v[28:31], v[176:179], a[232:235], 0
    v_mfma_f32_16x16x32_bf16 v[28:31], v[180:183], a[236:239], v[28:31]
    v_mfma_f32_16x16x32_bf16 v[28:31], v[184:187], a[240:243], v[28:31]
    v_mfma_f32_16x16x32_bf16 v[28:31], v[188:191], a[244:247], v[28:31]
    s_nop 3
    v_max3_f32 v252, v252, v24, v25
    v_max3_f32 v252, v252, v26, v27
    s_nop 1
    v_max3_f32 v252, v252, v28, v29
    v_max3_f32 v252, v252, v30, v31
    v_mfma_f32_16x16x32_bf16 v[32:35], v[160:163], a[248:251], 0
    v_mfma_f32_16x16x32_bf16 v[32:35], v[164:167], a[252:255], v[32:35]
    v_mfma_f32_16x16x32_bf16 v[32:35], v[168:171], v[224:227], v[32:35]
    v_mfma_f32_16x16x32_bf16 v[32:35], v[172:175], v[228:231], v[32:35]
    v_mfma_f32_16x16x32_bf16 v[36:39], v[176:179], a[248:251], 0
    v_mfma_f32_16x16x32_bf16 v[36:39], v[180:183], a[252:255], v[36:39]
    v_mfma_f32_16x16x32_bf16 v[36:39], v[184:187], v[224:227], v[36:39]
    v_mfma_f32_16x16x32_bf16 v[36:39], v[188:191], v[228:231], v[36:39]
    s_nop 3
    v_max3_f32 v253, v253, v32, v33
    v_max3_f32 v253, v253, v34, v35
    s_nop 1
    v_max3_f32 v253, v253, v36, v37
    v_max3_f32 v253, v253, v38, v39
    v_mfma_f32_16x16x32_bf16 v[24:27], v[160:163], v[232:235], 0
    v_mfma_f32_16x16x32_bf16 v[24:27], v[164:167], v[236:239], v[24:27]
    v_mfma_f32_16x16x32_bf16 v[24:27], v[168:171], v[240:243], v[24:27]
    v_mfma_f32_16x16x32_bf16 v[24:27], v[172:175], v[244:247], v[24:27]
    v_mfma_f32_16x16x32_bf16 v[28:31], v[176:179], v[232:235], 0
    v_mfma_f32_16x16x32_bf16 v[28:31], v[180:183], v[236:239], v[28:31]
    v_mfma_f32_16x16x32_bf16 v[28:31], v[184:187], v[240:243], v[28:31]
    v_mfma_f32_16x16x32_bf16 v[28:31], v[188:191], v[244:247], v[28:31]
    s_nop 3
    v_max3_f32 v254, v254, v24, v25
    v_max3_f32 v254, v254, v26, v27
    s_nop 1
    v_max3_f32 v254, v254, v28, v29
    v_max3_f32 v254, v254, v30, v31
    s_add_u32 s39, s39, 8192
    s_sub_u32 s38, s38, 1
    s_cmp_lg_u32 s38, 0
    s_cbranch_scc1 L_mx
    ds_write_b128 v1, v[248:251]
    ds_write_b128 v1, v[252:255] offset:1024
    v_lshlrev_b32 v2, 4, v2
    v_add_u32 v3, 81920, v2
    s_waitcnt lgkmcnt(0)
    s_barrier
    ds_read_b128 v[160:163], v2 offset:0
    ds_read_b128 v[164:167], v2 offset:1024
    ds_read_b128 v[168:171], v2 offset:256
    ds_read_b128 v[172:175], v2 offset:1280
    ds_read_b128 v[176:179], v2 offset:512
    ds_read_b128 v[180:183], v2 offset:1536
    ds_read_b128 v[184:187], v2 offset:768
    ds_read_b128 v[188:191], v2 offset:1792
    s_waitcnt lgkmcnt(0)
    v_max3_f32 v248, v248, v160, v168
    v_max3_f32 v249, v249, v161, v169
    v_max3_f32 v250, v250, v162, v170
    v_max3_f32 v251, v251, v163, v171
    v_max3_f32 v252, v252, v164, v172
    v_max3_f32 v253, v253, v165, v173
    v_max3_f32 v254, v254, v166, v174
    v_max3_f32 v248, v248, v176, v184
    v_max3_f32 v249, v249, v177, v185
    v_max3_f32 v250, v250, v178, v186
    v_max3_f32 v251, v251, v179, v187
    v_max3_f32 v252, v252, v180, v188
    v_max3_f32 v253, v253, v181, v189
    v_max3_f32 v254, v254, v182, v190
    ds_read_b128 v[192:195], v2 offset:40960
    ds_read_b128 v[196:199], v2 offset:41984
    ds_read_b128 v[200:203], v2 offset:41216
    ds_read_b128 v[204:207], v2 offset:42240
    ds_read_b128 v[208:211], v2 offset:41472
    ds_read_b128 v[212:215], v2 offset:42496
    ds_read_b128 v[216:219], v2 offset:41728
    ds_read_b128 v[220:223], v2 offset:42752
    s_waitcnt lgkmcnt(0)
    v_max3_f32 v248, v248, v192, v200
    v_max3_f32 v249, v249, v193, v201
    v_max3_f32 v250, v250, v194, v202
    v_max3_f32 v251, v251, v195, v203
    v_max3_f32 v252, v252, v196, v204
    v_max3_f32 v253, v253, v197, v205
    v_max3_f32 v254, v254, v198, v206
    v_max3_f32 v248, v248, v208, v216
    v_max3_f32 v249, v249, v209, v217
    v_max3_f32 v250, v250, v210, v218
    v_max3_f32 v251, v251, v211, v219
    v_max3_f32 v252, v252, v212, v220
    v_max3_f32 v253, v253, v213, v221
    v_max3_f32 v254, v254, v214, v222
    ds_read_b128 v[160:163], v3 offset:0
    ds_read_b128 v[164:167], v3 offset:1024
    ds_read_b128 v[168:171], v3 offset:256
    ds_read_b128 v[172:175], v3 offset:1280
    ds_read_b128 v[176:179], v3 offset:512
    ds_read_b128 v[180:183], v3 offset:1536
    ds_read_b128 v[184:187], v3 offset:768
    ds_read_b128 v[188:191], v3 offset:1792
    s_waitcnt lgkmcnt(0)
    v_max3_f32 v248, v248, v160, v168
    v_max3_f32 v249, v249, v161, v169
    v_max3_f32 v250, v250, v162, v170
    v_max3_f32 v251, v251, v163, v171
    v_max3_f32 v252, v252, v164, v172
    v_max3_f32 v253, v253, v165, v173
    v_max3_f32 v254, v254, v166, v174
    v_max3_f32 v248, v248, v176, v184
    v_max3_f32 v249, v249, v177, v185
    v_max3_f32 v250, v250, v178, v186
    v_max3_f32 v251, v251, v179, v187
    v_max3_f32 v252, v252, v180, v188
    v_max3_f32 v253, v253, v181, v189
    v_max3_f32 v254, v254, v182, v190
    ds_read_b128 v[192:195], v3 offset:40960
    ds_read_b128 v[196:199], v3 offset:41984
    ds_read_b128 v[200:203], v3 offset:41216
    ds_read_b128 v[204:207], v3 offset:42240
    ds_read_b128 v[208:211], v3 offset:41472
    ds_read_b128 v[212:215], v3 offset:42496
    ds_read_b128 v[216:219], v3 offset:41728
    ds_read_b128 v[220:223], v3 offset:42752
    s_waitcnt lgkmcnt(0)
    v_max3_f32 v248, v248, v192, v200
    v_max3_f32 v249, v249, v193, v201
    v_max3_f32 v250, v250, v194, v202
    v_max3_f32 v251, v251, v195, v203
    v_max3_f32 v252, v252, v196, v204
    v_max3_f32 v253, v253, v197, v205
    v_max3_f32 v254, v254, v198, v206
    v_max3_f32 v248, v248, v208, v216
    v_max3_f32 v249, v249, v209, v217
    v_max3_f32 v250, v250, v210, v218
    v_max3_f32 v251, v251, v211, v219
    v_max3_f32 v252, v252, v212, v220
    v_max3_f32 v253, v253, v213, v221
    v_max3_f32 v254, v254, v214, v222
    v_sub_f32 v48, 0, v248
    v_sub_f32 v49, 0, v248
    v_sub_f32 v50, 0, v248
    v_sub_f32 v51, 0, v248
    v_sub_f32 v52, 0, v249
    v_sub_f32 v53, 0, v249
    v_sub_f32 v54, 0, v249
    v_sub_f32 v55, 0, v249
    v_sub_f32 v56, 0, v250
    v_sub_f32 v57, 0, v250
    v_sub_f32 v58, 0, v250
    v_sub_f32 v59, 0, v250
    v_sub_f32 v60, 0, v251
    v_sub_f32 v61, 0, v251
    v_sub_f32 v62, 0, v251
    v_sub_f32 v63, 0, v251
    v_sub_f32 v64, 0, v252
    v_sub_f32 v65, 0, v252
    v_sub_f32 v66, 0, v252
    v_sub_f32 v67, 0, v252
    v_sub_f32 v68, 0, v253
    v_sub_f32 v69, 0, v253
    v_sub_f32 v70, 0, v253
    v_sub_f32 v71, 0, v253
    v_sub_f32 v72, 0, v254
    v_sub_f32 v73, 0, v254
    v_sub_f32 v74, 0, v254
    v_sub_f32 v75, 0, v254
    s_barrier
    s_mov_b32 s3, 0
    s_mov_b64 vcc, 0
    s_load_dwordx8 s[4:11], s[0:1], 0
    s_branch L_start
.section .rodata,"a"
.p2align 6
.amdhsa_kernel standalone__gqa_softmax__near_ridge_kernel
  .amdhsa_next_free_vgpr 512
  .amdhsa_next_free_sgpr 102
  .amdhsa_accum_offset 256
  .amdhsa_group_segment_fixed_size 0
  .amdhsa_kernarg_size 48
  .amdhsa_user_sgpr_count 2
  .amdhsa_user_sgpr_kernarg_segment_ptr 1
  .amdhsa_system_sgpr_workgroup_id_x 1
.end_amdhsa_kernel
```
